```python
import torch

def _softmax(x, axis=-1):
    return torch.softmax(x, dim=axis)
def _gelu(x):
    return torch.nn.functional.gelu(x, approximate="tanh")
def _silu(x):
    return torch.nn.functional.silu(x)
def _sigmoid(x):
    return torch.sigmoid(x)
def _layernorm(x, axis=-1, eps=1e-5):
    m = x.mean(dim=axis, keepdim=True)
    v = x.var(dim=axis, keepdim=True, unbiased=False)
    return (x - m) / torch.sqrt(v + eps)
def _scatter_add(tgt, idx, src, axis=0):
    return tgt.clone().index_add_(axis, idx, src)
def _segment_sum(src, seg, n):
    out = torch.zeros((n,) + src.shape[1:], dtype=src.dtype)
    return out.index_add_(0, seg, src)
def _pad(x, pw):
    flat = tuple(v for pair in reversed(pw) for v in pair)
    return torch.nn.functional.pad(x, flat)

kernel_name = 'recurrent_scan__spectral_fnet__mixer_channel_mlp__prompt'

def setup_inputs():

    _w = (lambda a: (lambda t: t.to(torch.bfloat16) if t.is_floating_point() else t)(torch.as_tensor(a)))
    def _A_setup():
        B, S, D = 1, 2048, 576
        ns = torch.arange(S)[:, None] * torch.arange(S)[None, :]
        nd = torch.arange(D)[:, None] * torch.arange(D)[None, :]
        Ws_re = torch.cos(-2.0 * torch.pi * ns / S).to(float)
        Ws_im = torch.sin(-2.0 * torch.pi * ns / S).to(float)
        Wd_re = torch.cos(-2.0 * torch.pi * nd / D).to(float)
        Wd_im = torch.sin(-2.0 * torch.pi * nd / D).to(float)
        return {
            "x": _w((lambda *s: torch.randn(*s, dtype=torch.bfloat16) * 0.05)(B, S, D)),
            "dft_seq_re": _w(Ws_re),
            "dft_seq_im": _w(Ws_im),
            "dft_hid_re": _w(Wd_re),
            "dft_hid_im": _w(Wd_im),
        }
    _A_in = _A_setup()

    def _B_setup():
        B, S, D, F = 1, 2048, 576, 4608
        return {
            "x": _w((lambda *s: torch.randn(*s, dtype=torch.bfloat16) * 0.05)(B, S, D)),
            "w1": _w((lambda *s: torch.randn(*s, dtype=torch.bfloat16) * 0.8)(D, F) * (D ** -0.5)),
            "b1": _w((lambda *s: torch.randn(*s, dtype=torch.bfloat16) * 0.8)(F)),
            "w2": _w((lambda *s: torch.randn(*s, dtype=torch.bfloat16) * 0.05)(F, D) * (F ** -0.5)),
            "b2": _w((lambda *s: torch.randn(*s, dtype=torch.bfloat16) * 0.05)(D)),
        }
    _B_in = _B_setup()

    return {
        "A_x": _A_in["x"],
        "A_dft_seq_re": _A_in["dft_seq_re"],
        "A_dft_seq_im": _A_in["dft_seq_im"],
        "A_dft_hid_re": _A_in["dft_hid_re"],
        "A_dft_hid_im": _A_in["dft_hid_im"],
        "B_x": _B_in["x"],
        "B_w1": _B_in["w1"],
        "B_b1": _B_in["b1"],
        "B_w2": _B_in["w2"],
        "B_b2": _B_in["b2"],
    }

def reference(A_x, A_dft_seq_re, A_dft_seq_im, A_dft_hid_re, A_dft_hid_im, B_x, B_w1, B_b1, B_w2, B_b2):
    def _A_ref(x, dft_seq_re, dft_seq_im, dft_hid_re, dft_hid_im):
        a = torch.einsum("bsd,ed->bse", x, dft_hid_re)
        b = torch.einsum("bsd,ed->bse", x, dft_hid_im)
        y = torch.einsum("ts,bse->bte", dft_seq_re, a) - torch.einsum("ts,bse->bte", dft_seq_im, b)
        return y

    def _B_ref(x, w1, b1, w2, b2):
        y = _layernorm(x, axis=-1)
        h = _gelu(torch.einsum("bsd,df->bsf", y, w1) + b1)
        return torch.einsum("bsf,fd->bsd", h, w2) + b2

    x = A_x
    xn = _layernorm(x, axis=-1)
    s = _A_ref(xn, A_dft_seq_re, A_dft_seq_im, A_dft_hid_re, A_dft_hid_im)
    g = _silu(_B_ref(xn, B_w1, B_b1, B_w2, B_b2))
    return x + s * g
```

```asm
; @launch kernel=ln_kernel grid=(256,1,1) block=(256,1,1) lds=0
; @launch kernel=gemm1_kernel grid=(256,1,1) block=(512,1,1) lds=159744
; @launch kernel=gemm2_kernel grid=(256,1,1) block=(512,1,1) lds=151552
.amdgcn_target "amdgcn-amd-amdhsa--gfx950"
.text
.globl ln_kernel
.p2align 8
.type ln_kernel,@function
ln_kernel:
    s_cmp_ge_u32 s2, 256
    s_cbranch_scc1 L_ln_done
    s_load_dwordx2 s[4:5], s[0:1], 0
    s_load_dwordx2 s[6:7], s[0:1], 96
    v_lshrrev_b32 v1, 5, v0
    s_lshl_b32 s3, s2, 3
    v_add_u32 v1, s3, v1
    v_and_b32 v2, 31, v0
    v_mul_u32_u24 v1, 1152, v1
    v_lshl_add_u32 v1, v2, 2, v1
    s_waitcnt lgkmcnt(0)
    s_mov_b32 s8, s4
    s_mov_b32 s9, s5
    s_mov_b32 s10, 2359296
    s_mov_b32 s11, 0x00020000
    s_mov_b32 s12, s6
    s_mov_b32 s13, s7
    s_mov_b32 s14, 4718592
    s_mov_b32 s15, 0x00020000
    s_add_u32 s20, s6, 47185920
    s_addc_u32 s21, s7, 0
    s_mov_b32 s22, 8192
    s_mov_b32 s23, 0x00020000
    s_lshl_b32 s3, s2, 8
    v_add_u32 v3, s3, v0
    v_mov_b32 v4, 0
    buffer_store_byte v4, v3, s[20:23], 0 offen
    buffer_load_dword v10, v1, s[8:11], 0 offen offset:0
    buffer_load_dword v11, v1, s[8:11], 0 offen offset:128
    buffer_load_dword v12, v1, s[8:11], 0 offen offset:256
    buffer_load_dword v13, v1, s[8:11], 0 offen offset:384
    buffer_load_dword v14, v1, s[8:11], 0 offen offset:512
    buffer_load_dword v15, v1, s[8:11], 0 offen offset:640
    buffer_load_dword v16, v1, s[8:11], 0 offen offset:768
    buffer_load_dword v17, v1, s[8:11], 0 offen offset:896
    buffer_load_dword v18, v1, s[8:11], 0 offen offset:1024
    s_mov_b32 s16, 0xffff0000
    s_mov_b32 s17, 0x3ae38e39
    s_mov_b32 s18, 0x3727c5ac
    s_waitcnt vmcnt(0)
    v_lshlrev_b32 v20, 16, v10
    v_and_b32 v21, s16, v10
    v_lshlrev_b32 v22, 16, v11
    v_and_b32 v23, s16, v11
    v_lshlrev_b32 v24, 16, v12
    v_and_b32 v25, s16, v12
    v_lshlrev_b32 v26, 16, v13
    v_and_b32 v27, s16, v13
    v_lshlrev_b32 v28, 16, v14
    v_and_b32 v29, s16, v14
    v_lshlrev_b32 v30, 16, v15
    v_and_b32 v31, s16, v15
    v_lshlrev_b32 v32, 16, v16
    v_and_b32 v33, s16, v16
    v_lshlrev_b32 v34, 16, v17
    v_and_b32 v35, s16, v17
    v_lshlrev_b32 v36, 16, v18
    v_and_b32 v37, s16, v18
    v_add_f32 v40, v20, v21
    v_add_f32 v40, v40, v22
    v_add_f32 v40, v40, v23
    v_add_f32 v40, v40, v24
    v_add_f32 v40, v40, v25
    v_add_f32 v40, v40, v26
    v_add_f32 v40, v40, v27
    v_add_f32 v40, v40, v28
    v_add_f32 v40, v40, v29
    v_add_f32 v40, v40, v30
    v_add_f32 v40, v40, v31
    v_add_f32 v40, v40, v32
    v_add_f32 v40, v40, v33
    v_add_f32 v40, v40, v34
    v_add_f32 v40, v40, v35
    v_add_f32 v40, v40, v36
    v_add_f32 v40, v40, v37
    s_nop 1
    v_add_f32_dpp v40, v40, v40 row_ror:8 row_mask:0xf bank_mask:0xf
    s_nop 1
    v_add_f32_dpp v40, v40, v40 row_ror:4 row_mask:0xf bank_mask:0xf
    s_nop 1
    v_add_f32_dpp v40, v40, v40 row_ror:2 row_mask:0xf bank_mask:0xf
    s_nop 1
    v_add_f32_dpp v40, v40, v40 row_ror:1 row_mask:0xf bank_mask:0xf
    ds_swizzle_b32 v41, v40 offset:0x401F
    s_waitcnt lgkmcnt(0)
    v_add_f32 v40, v40, v41
    v_mul_f32 v42, s17, v40
    v_sub_f32 v50, v20, v42
    v_sub_f32 v51, v21, v42
    v_sub_f32 v52, v22, v42
    v_sub_f32 v53, v23, v42
    v_sub_f32 v54, v24, v42
    v_sub_f32 v55, v25, v42
    v_sub_f32 v56, v26, v42
    v_sub_f32 v57, v27, v42
    v_sub_f32 v58, v28, v42
    v_sub_f32 v59, v29, v42
    v_sub_f32 v60, v30, v42
    v_sub_f32 v61, v31, v42
    v_sub_f32 v62, v32, v42
    v_sub_f32 v63, v33, v42
    v_sub_f32 v64, v34, v42
    v_sub_f32 v65, v35, v42
    v_sub_f32 v66, v36, v42
    v_sub_f32 v67, v37, v42
    v_mul_f32 v40, v50, v50
    v_fmac_f32 v40, v51, v51
    v_fmac_f32 v40, v52, v52
    v_fmac_f32 v40, v53, v53
    v_fmac_f32 v40, v54, v54
    v_fmac_f32 v40, v55, v55
    v_fmac_f32 v40, v56, v56
    v_fmac_f32 v40, v57, v57
    v_fmac_f32 v40, v58, v58
    v_fmac_f32 v40, v59, v59
    v_fmac_f32 v40, v60, v60
    v_fmac_f32 v40, v61, v61
    v_fmac_f32 v40, v62, v62
    v_fmac_f32 v40, v63, v63
    v_fmac_f32 v40, v64, v64
    v_fmac_f32 v40, v65, v65
    v_fmac_f32 v40, v66, v66
    v_fmac_f32 v40, v67, v67
    s_nop 1
    v_add_f32_dpp v40, v40, v40 row_ror:8 row_mask:0xf bank_mask:0xf
    s_nop 1
    v_add_f32_dpp v40, v40, v40 row_ror:4 row_mask:0xf bank_mask:0xf
    s_nop 1
    v_add_f32_dpp v40, v40, v40 row_ror:2 row_mask:0xf bank_mask:0xf
    s_nop 1
    v_add_f32_dpp v40, v40, v40 row_ror:1 row_mask:0xf bank_mask:0xf
    ds_swizzle_b32 v41, v40 offset:0x401F
    s_waitcnt lgkmcnt(0)
    v_add_f32 v40, v40, v41
    v_mul_f32 v43, s17, v40
    v_cvt_pk_bf16_f32 v43, v43, v43
    v_lshlrev_b32 v43, 16, v43
    v_add_f32 v43, s18, v43
    v_cvt_pk_bf16_f32 v43, v43, v43
    v_lshlrev_b32 v43, 16, v43
    v_sqrt_f32 v43, v43
    s_nop 0
    v_cvt_pk_bf16_f32 v43, v43, v43
    v_lshlrev_b32 v43, 16, v43
    v_cvt_pk_bf16_f32 v42, v42, v42
    v_lshlrev_b32 v42, 16, v42
    v_rcp_f32 v44, v43
    v_sub_f32 v50, v20, v42
    v_sub_f32 v51, v21, v42
    v_sub_f32 v52, v22, v42
    v_sub_f32 v53, v23, v42
    v_sub_f32 v54, v24, v42
    v_sub_f32 v55, v25, v42
    v_sub_f32 v56, v26, v42
    v_sub_f32 v57, v27, v42
    v_sub_f32 v58, v28, v42
    v_sub_f32 v59, v29, v42
    v_sub_f32 v60, v30, v42
    v_sub_f32 v61, v31, v42
    v_sub_f32 v62, v32, v42
    v_sub_f32 v63, v33, v42
    v_sub_f32 v64, v34, v42
    v_sub_f32 v65, v35, v42
    v_sub_f32 v66, v36, v42
    v_sub_f32 v67, v37, v42
    v_cvt_pk_bf16_f32 v10, v50, v51
    v_lshlrev_b32 v50, 16, v10
    v_and_b32 v51, s16, v10
    v_cvt_pk_bf16_f32 v11, v52, v53
    v_lshlrev_b32 v52, 16, v11
    v_and_b32 v53, s16, v11
    v_cvt_pk_bf16_f32 v12, v54, v55
    v_lshlrev_b32 v54, 16, v12
    v_and_b32 v55, s16, v12
    v_cvt_pk_bf16_f32 v13, v56, v57
    v_lshlrev_b32 v56, 16, v13
    v_and_b32 v57, s16, v13
    v_cvt_pk_bf16_f32 v14, v58, v59
    v_lshlrev_b32 v58, 16, v14
    v_and_b32 v59, s16, v14
    v_cvt_pk_bf16_f32 v15, v60, v61
    v_lshlrev_b32 v60, 16, v15
    v_and_b32 v61, s16, v15
    v_cvt_pk_bf16_f32 v16, v62, v63
    v_lshlrev_b32 v62, 16, v16
    v_and_b32 v63, s16, v16
    v_cvt_pk_bf16_f32 v17, v64, v65
    v_lshlrev_b32 v64, 16, v17
    v_and_b32 v65, s16, v17
    v_cvt_pk_bf16_f32 v18, v66, v67
    v_lshlrev_b32 v66, 16, v18
    v_and_b32 v67, s16, v18
    v_mul_f32 v45, v50, v44
    v_fma_f32 v46, -v45, v43, v50
    v_fma_f32 v20, v46, v44, v45
    v_mul_f32 v45, v51, v44
    v_fma_f32 v46, -v45, v43, v51
    v_fma_f32 v21, v46, v44, v45
    v_mul_f32 v45, v52, v44
    v_fma_f32 v46, -v45, v43, v52
    v_fma_f32 v22, v46, v44, v45
    v_mul_f32 v45, v53, v44
    v_fma_f32 v46, -v45, v43, v53
    v_fma_f32 v23, v46, v44, v45
    v_mul_f32 v45, v54, v44
    v_fma_f32 v46, -v45, v43, v54
    v_fma_f32 v24, v46, v44, v45
    v_mul_f32 v45, v55, v44
    v_fma_f32 v46, -v45, v43, v55
    v_fma_f32 v25, v46, v44, v45
    v_mul_f32 v45, v56, v44
    v_fma_f32 v46, -v45, v43, v56
    v_fma_f32 v26, v46, v44, v45
    v_mul_f32 v45, v57, v44
    v_fma_f32 v46, -v45, v43, v57
    v_fma_f32 v27, v46, v44, v45
    v_mul_f32 v45, v58, v44
    v_fma_f32 v46, -v45, v43, v58
    v_fma_f32 v28, v46, v44, v45
    v_mul_f32 v45, v59, v44
    v_fma_f32 v46, -v45, v43, v59
    v_fma_f32 v29, v46, v44, v45
    v_mul_f32 v45, v60, v44
    v_fma_f32 v46, -v45, v43, v60
    v_fma_f32 v30, v46, v44, v45
    v_mul_f32 v45, v61, v44
    v_fma_f32 v46, -v45, v43, v61
    v_fma_f32 v31, v46, v44, v45
    v_mul_f32 v45, v62, v44
    v_fma_f32 v46, -v45, v43, v62
    v_fma_f32 v32, v46, v44, v45
    v_mul_f32 v45, v63, v44
    v_fma_f32 v46, -v45, v43, v63
    v_fma_f32 v33, v46, v44, v45
    v_mul_f32 v45, v64, v44
    v_fma_f32 v46, -v45, v43, v64
    v_fma_f32 v34, v46, v44, v45
    v_mul_f32 v45, v65, v44
    v_fma_f32 v46, -v45, v43, v65
    v_fma_f32 v35, v46, v44, v45
    v_mul_f32 v45, v66, v44
    v_fma_f32 v46, -v45, v43, v66
    v_fma_f32 v36, v46, v44, v45
    v_mul_f32 v45, v67, v44
    v_fma_f32 v46, -v45, v43, v67
    v_fma_f32 v37, v46, v44, v45
    v_cvt_pk_bf16_f32 v10, v20, v21
    v_lshlrev_b32 v20, 16, v10
    v_and_b32 v21, s16, v10
    v_cvt_pk_bf16_f32 v11, v22, v23
    v_lshlrev_b32 v22, 16, v11
    v_and_b32 v23, s16, v11
    v_cvt_pk_bf16_f32 v12, v24, v25
    v_lshlrev_b32 v24, 16, v12
    v_and_b32 v25, s16, v12
    v_cvt_pk_bf16_f32 v13, v26, v27
    v_lshlrev_b32 v26, 16, v13
    v_and_b32 v27, s16, v13
    v_cvt_pk_bf16_f32 v14, v28, v29
    v_lshlrev_b32 v28, 16, v14
    v_and_b32 v29, s16, v14
    v_cvt_pk_bf16_f32 v15, v30, v31
    v_lshlrev_b32 v30, 16, v15
    v_and_b32 v31, s16, v15
    v_cvt_pk_bf16_f32 v16, v32, v33
    v_lshlrev_b32 v32, 16, v16
    v_and_b32 v33, s16, v16
    v_cvt_pk_bf16_f32 v17, v34, v35
    v_lshlrev_b32 v34, 16, v17
    v_and_b32 v35, s16, v17
    v_cvt_pk_bf16_f32 v18, v36, v37
    v_lshlrev_b32 v36, 16, v18
    v_and_b32 v37, s16, v18
    s_mov_b32 s19, 0
    buffer_store_dword v10, v1, s[12:15], s19 offen offset:0
    buffer_store_dword v11, v1, s[12:15], s19 offen offset:128
    buffer_store_dword v12, v1, s[12:15], s19 offen offset:256
    buffer_store_dword v13, v1, s[12:15], s19 offen offset:384
    buffer_store_dword v14, v1, s[12:15], s19 offen offset:512
    buffer_store_dword v15, v1, s[12:15], s19 offen offset:640
    buffer_store_dword v16, v1, s[12:15], s19 offen offset:768
    buffer_store_dword v17, v1, s[12:15], s19 offen offset:896
    buffer_store_dword v18, v1, s[12:15], s19 offen offset:1024
    s_nop 1
    v_add_f32 v40, v20, v21
    v_add_f32 v40, v40, v22
    v_add_f32 v40, v40, v23
    v_add_f32 v40, v40, v24
    v_add_f32 v40, v40, v25
    v_add_f32 v40, v40, v26
    v_add_f32 v40, v40, v27
    v_add_f32 v40, v40, v28
    v_add_f32 v40, v40, v29
    v_add_f32 v40, v40, v30
    v_add_f32 v40, v40, v31
    v_add_f32 v40, v40, v32
    v_add_f32 v40, v40, v33
    v_add_f32 v40, v40, v34
    v_add_f32 v40, v40, v35
    v_add_f32 v40, v40, v36
    v_add_f32 v40, v40, v37
    s_nop 1
    v_add_f32_dpp v40, v40, v40 row_ror:8 row_mask:0xf bank_mask:0xf
    s_nop 1
    v_add_f32_dpp v40, v40, v40 row_ror:4 row_mask:0xf bank_mask:0xf
    s_nop 1
    v_add_f32_dpp v40, v40, v40 row_ror:2 row_mask:0xf bank_mask:0xf
    s_nop 1
    v_add_f32_dpp v40, v40, v40 row_ror:1 row_mask:0xf bank_mask:0xf
    ds_swizzle_b32 v41, v40 offset:0x401F
    s_waitcnt lgkmcnt(0)
    v_add_f32 v40, v40, v41
    v_mul_f32 v42, s17, v40
    v_sub_f32 v50, v20, v42
    v_sub_f32 v51, v21, v42
    v_sub_f32 v52, v22, v42
    v_sub_f32 v53, v23, v42
    v_sub_f32 v54, v24, v42
    v_sub_f32 v55, v25, v42
    v_sub_f32 v56, v26, v42
    v_sub_f32 v57, v27, v42
    v_sub_f32 v58, v28, v42
    v_sub_f32 v59, v29, v42
    v_sub_f32 v60, v30, v42
    v_sub_f32 v61, v31, v42
    v_sub_f32 v62, v32, v42
    v_sub_f32 v63, v33, v42
    v_sub_f32 v64, v34, v42
    v_sub_f32 v65, v35, v42
    v_sub_f32 v66, v36, v42
    v_sub_f32 v67, v37, v42
    v_mul_f32 v40, v50, v50
    v_fmac_f32 v40, v51, v51
    v_fmac_f32 v40, v52, v52
    v_fmac_f32 v40, v53, v53
    v_fmac_f32 v40, v54, v54
    v_fmac_f32 v40, v55, v55
    v_fmac_f32 v40, v56, v56
    v_fmac_f32 v40, v57, v57
    v_fmac_f32 v40, v58, v58
    v_fmac_f32 v40, v59, v59
    v_fmac_f32 v40, v60, v60
    v_fmac_f32 v40, v61, v61
    v_fmac_f32 v40, v62, v62
    v_fmac_f32 v40, v63, v63
    v_fmac_f32 v40, v64, v64
    v_fmac_f32 v40, v65, v65
    v_fmac_f32 v40, v66, v66
    v_fmac_f32 v40, v67, v67
    s_nop 1
    v_add_f32_dpp v40, v40, v40 row_ror:8 row_mask:0xf bank_mask:0xf
    s_nop 1
    v_add_f32_dpp v40, v40, v40 row_ror:4 row_mask:0xf bank_mask:0xf
    s_nop 1
    v_add_f32_dpp v40, v40, v40 row_ror:2 row_mask:0xf bank_mask:0xf
    s_nop 1
    v_add_f32_dpp v40, v40, v40 row_ror:1 row_mask:0xf bank_mask:0xf
    ds_swizzle_b32 v41, v40 offset:0x401F
    s_waitcnt lgkmcnt(0)
    v_add_f32 v40, v40, v41
    v_mul_f32 v43, s17, v40
    v_cvt_pk_bf16_f32 v43, v43, v43
    v_lshlrev_b32 v43, 16, v43
    v_add_f32 v43, s18, v43
    v_cvt_pk_bf16_f32 v43, v43, v43
    v_lshlrev_b32 v43, 16, v43
    v_sqrt_f32 v43, v43
    s_nop 0
    v_cvt_pk_bf16_f32 v43, v43, v43
    v_lshlrev_b32 v43, 16, v43
    v_cvt_pk_bf16_f32 v42, v42, v42
    v_lshlrev_b32 v42, 16, v42
    v_rcp_f32 v44, v43
    v_sub_f32 v50, v20, v42
    v_sub_f32 v51, v21, v42
    v_sub_f32 v52, v22, v42
    v_sub_f32 v53, v23, v42
    v_sub_f32 v54, v24, v42
    v_sub_f32 v55, v25, v42
    v_sub_f32 v56, v26, v42
    v_sub_f32 v57, v27, v42
    v_sub_f32 v58, v28, v42
    v_sub_f32 v59, v29, v42
    v_sub_f32 v60, v30, v42
    v_sub_f32 v61, v31, v42
    v_sub_f32 v62, v32, v42
    v_sub_f32 v63, v33, v42
    v_sub_f32 v64, v34, v42
    v_sub_f32 v65, v35, v42
    v_sub_f32 v66, v36, v42
    v_sub_f32 v67, v37, v42
    v_cvt_pk_bf16_f32 v10, v50, v51
    v_lshlrev_b32 v50, 16, v10
    v_and_b32 v51, s16, v10
    v_cvt_pk_bf16_f32 v11, v52, v53
    v_lshlrev_b32 v52, 16, v11
    v_and_b32 v53, s16, v11
    v_cvt_pk_bf16_f32 v12, v54, v55
    v_lshlrev_b32 v54, 16, v12
    v_and_b32 v55, s16, v12
    v_cvt_pk_bf16_f32 v13, v56, v57
    v_lshlrev_b32 v56, 16, v13
    v_and_b32 v57, s16, v13
    v_cvt_pk_bf16_f32 v14, v58, v59
    v_lshlrev_b32 v58, 16, v14
    v_and_b32 v59, s16, v14
    v_cvt_pk_bf16_f32 v15, v60, v61
    v_lshlrev_b32 v60, 16, v15
    v_and_b32 v61, s16, v15
    v_cvt_pk_bf16_f32 v16, v62, v63
    v_lshlrev_b32 v62, 16, v16
    v_and_b32 v63, s16, v16
    v_cvt_pk_bf16_f32 v17, v64, v65
    v_lshlrev_b32 v64, 16, v17
    v_and_b32 v65, s16, v17
    v_cvt_pk_bf16_f32 v18, v66, v67
    v_lshlrev_b32 v66, 16, v18
    v_and_b32 v67, s16, v18
    v_mul_f32 v45, v50, v44
    v_fma_f32 v46, -v45, v43, v50
    v_fma_f32 v20, v46, v44, v45
    v_mul_f32 v45, v51, v44
    v_fma_f32 v46, -v45, v43, v51
    v_fma_f32 v21, v46, v44, v45
    v_mul_f32 v45, v52, v44
    v_fma_f32 v46, -v45, v43, v52
    v_fma_f32 v22, v46, v44, v45
    v_mul_f32 v45, v53, v44
    v_fma_f32 v46, -v45, v43, v53
    v_fma_f32 v23, v46, v44, v45
    v_mul_f32 v45, v54, v44
    v_fma_f32 v46, -v45, v43, v54
    v_fma_f32 v24, v46, v44, v45
    v_mul_f32 v45, v55, v44
    v_fma_f32 v46, -v45, v43, v55
    v_fma_f32 v25, v46, v44, v45
    v_mul_f32 v45, v56, v44
    v_fma_f32 v46, -v45, v43, v56
    v_fma_f32 v26, v46, v44, v45
    v_mul_f32 v45, v57, v44
    v_fma_f32 v46, -v45, v43, v57
    v_fma_f32 v27, v46, v44, v45
    v_mul_f32 v45, v58, v44
    v_fma_f32 v46, -v45, v43, v58
    v_fma_f32 v28, v46, v44, v45
    v_mul_f32 v45, v59, v44
    v_fma_f32 v46, -v45, v43, v59
    v_fma_f32 v29, v46, v44, v45
    v_mul_f32 v45, v60, v44
    v_fma_f32 v46, -v45, v43, v60
    v_fma_f32 v30, v46, v44, v45
    v_mul_f32 v45, v61, v44
    v_fma_f32 v46, -v45, v43, v61
    v_fma_f32 v31, v46, v44, v45
    v_mul_f32 v45, v62, v44
    v_fma_f32 v46, -v45, v43, v62
    v_fma_f32 v32, v46, v44, v45
    v_mul_f32 v45, v63, v44
    v_fma_f32 v46, -v45, v43, v63
    v_fma_f32 v33, v46, v44, v45
    v_mul_f32 v45, v64, v44
    v_fma_f32 v46, -v45, v43, v64
    v_fma_f32 v34, v46, v44, v45
    v_mul_f32 v45, v65, v44
    v_fma_f32 v46, -v45, v43, v65
    v_fma_f32 v35, v46, v44, v45
    v_mul_f32 v45, v66, v44
    v_fma_f32 v46, -v45, v43, v66
    v_fma_f32 v36, v46, v44, v45
    v_mul_f32 v45, v67, v44
    v_fma_f32 v46, -v45, v43, v67
    v_fma_f32 v37, v46, v44, v45
    v_cvt_pk_bf16_f32 v10, v20, v21
    v_lshlrev_b32 v20, 16, v10
    v_and_b32 v21, s16, v10
    v_cvt_pk_bf16_f32 v11, v22, v23
    v_lshlrev_b32 v22, 16, v11
    v_and_b32 v23, s16, v11
    v_cvt_pk_bf16_f32 v12, v24, v25
    v_lshlrev_b32 v24, 16, v12
    v_and_b32 v25, s16, v12
    v_cvt_pk_bf16_f32 v13, v26, v27
    v_lshlrev_b32 v26, 16, v13
    v_and_b32 v27, s16, v13
    v_cvt_pk_bf16_f32 v14, v28, v29
    v_lshlrev_b32 v28, 16, v14
    v_and_b32 v29, s16, v14
    v_cvt_pk_bf16_f32 v15, v30, v31
    v_lshlrev_b32 v30, 16, v15
    v_and_b32 v31, s16, v15
    v_cvt_pk_bf16_f32 v16, v32, v33
    v_lshlrev_b32 v32, 16, v16
    v_and_b32 v33, s16, v16
    v_cvt_pk_bf16_f32 v17, v34, v35
    v_lshlrev_b32 v34, 16, v17
    v_and_b32 v35, s16, v17
    v_cvt_pk_bf16_f32 v18, v36, v37
    v_lshlrev_b32 v36, 16, v18
    v_and_b32 v37, s16, v18
    s_mov_b32 s19, 2359296
    buffer_store_dword v10, v1, s[12:15], s19 offen offset:0
    buffer_store_dword v11, v1, s[12:15], s19 offen offset:128
    buffer_store_dword v12, v1, s[12:15], s19 offen offset:256
    buffer_store_dword v13, v1, s[12:15], s19 offen offset:384
    buffer_store_dword v14, v1, s[12:15], s19 offen offset:512
    buffer_store_dword v15, v1, s[12:15], s19 offen offset:640
    buffer_store_dword v16, v1, s[12:15], s19 offen offset:768
    buffer_store_dword v17, v1, s[12:15], s19 offen offset:896
    buffer_store_dword v18, v1, s[12:15], s19 offen offset:1024
L_ln_done:
    s_endpgm
.text
.globl gemm1_kernel
.p2align 8
.type gemm1_kernel,@function
gemm1_kernel:
    s_cmp_ge_u32 s2, 256
    s_cbranch_scc1 L_k1_done
    s_cmp_ge_u32 s2, 240
    s_cbranch_scc1 L_k1_copy
    s_load_dwordx4 s[4:7], s[0:1], 24
    s_load_dwordx4 s[8:11], s[0:1], 48
    s_load_dwordx2 s[12:13], s[0:1], 96
    v_lshrrev_b32 v1, 6, v0
    v_and_b32 v2, 63, v0
    s_and_b32 s33, s2, 7
    s_lshr_b32 s34, s2, 3
    s_mul_i32 s33, s33, 30
    s_add_u32 s34, s34, s33
    s_and_b32 s33, s34, 7
    s_lshr_b32 s34, s34, 3
    v_readfirstlane_b32 s32, v1
    s_lshl_b32 s33, s33, 8
    s_waitcnt lgkmcnt(0)
    s_cmp_ge_u32 s34, 24
    s_cbranch_scc1 L_k1_nt
    s_add_u32 s16, s12, 2359296
    s_addc_u32 s17, s13, 0
    s_mov_b32 s18, 2359296
    s_mov_b32 s19, 0x00020000
    s_mov_b32 s20, s8
    s_mov_b32 s21, s9
    s_mov_b32 s22, 5308416
    s_mov_b32 s23, 0x00020000
    s_add_u32 s24, s12, 9437184
    s_addc_u32 s25, s13, 0
    s_mov_b32 s26, 18874368
    s_mov_b32 s27, 0x00020000
    s_mov_b32 s28, s10
    s_mov_b32 s29, s11
    s_mov_b32 s30, 9216
    s_mov_b32 s31, 0x00020000
    s_mul_i32 s34, s34, 192
    s_cmp_ge_u32 s32, 4
    s_cbranch_scc1 L_k1_nn_loader
    s_lshr_b32 s36, s32, 1
    s_and_b32 s37, s32, 1
    v_and_b32 v3, 31, v2
    v_lshrrev_b32 v4, 5, v2
    v_bfe_u32 v5, v2, 1, 3
    v_xor_b32 v6, v4, v5
    s_lshl_b32 s38, s36, 7
    v_add_u32 v7, s38, v3
    v_lshlrev_b32 v7, 7, v7
    v_lshl_add_u32 v48, v6, 4, v7
    v_xor_b32 v49, 32, v48
    v_xor_b32 v50, 64, v48
    v_xor_b32 v51, 96, v48
    v_bfe_u32 v3, v2, 2, 2
    v_lshl_add_u32 v3, v4, 3, v3
    v_mul_u32_u24 v3, 384, v3
    v_bfe_u32 v5, v2, 4, 1
    v_lshl_add_u32 v3, v5, 5, v3
    v_and_b32 v5, 3, v2
    v_lshl_add_u32 v3, v5, 3, v3
    s_mul_i32 s38, s37, 192
    s_add_u32 s38, s38, 98304
    v_add_u32 v3, s38, v3
    v_bfe_u32 v5, v2, 3, 1
    v_lshlrev_b32 v5, 6, v5
    v_add_u32 v52, v3, v5
    v_sub_u32 v53, v3, v5
    s_cmp_eq_u32 s37, 1
    s_cbranch_scc0 L_k1_noswap
    v_mov_b32 v3, v52
    v_mov_b32 v52, v53
    v_mov_b32 v53, v3
L_k1_noswap:
    s_mul_i32 s38, s37, 96
    s_add_u32 s38, s38, s34
    s_lshl_b32 s38, s38, 1
    v_lshlrev_b32 v3, 3, v4
    buffer_load_dwordx2 v[8:9], v3, s[28:31], s38 offen offset:0
    buffer_load_dwordx2 v[10:11], v3, s[28:31], s38 offen offset:16
    buffer_load_dwordx2 v[12:13], v3, s[28:31], s38 offen offset:32
    buffer_load_dwordx2 v[14:15], v3, s[28:31], s38 offen offset:48
    buffer_load_dwordx2 v[16:17], v3, s[28:31], s38 offen offset:64
    buffer_load_dwordx2 v[18:19], v3, s[28:31], s38 offen offset:80
    buffer_load_dwordx2 v[20:21], v3, s[28:31], s38 offen offset:96
    buffer_load_dwordx2 v[22:23], v3, s[28:31], s38 offen offset:112
    buffer_load_dwordx2 v[24:25], v3, s[28:31], s38 offen offset:128
    buffer_load_dwordx2 v[26:27], v3, s[28:31], s38 offen offset:144
    buffer_load_dwordx2 v[28:29], v3, s[28:31], s38 offen offset:160
    buffer_load_dwordx2 v[30:31], v3, s[28:31], s38 offen offset:176
    s_mov_b32 s38, 0xffff0000
    s_waitcnt vmcnt(0)
    v_lshlrev_b32 v64, 16, v8
    v_and_b32 v65, s38, v8
    v_lshlrev_b32 v66, 16, v9
    v_and_b32 v67, s38, v9
    v_lshlrev_b32 v68, 16, v10
    v_and_b32 v69, s38, v10
    v_lshlrev_b32 v70, 16, v11
    v_and_b32 v71, s38, v11
    v_lshlrev_b32 v72, 16, v12
    v_and_b32 v73, s38, v12
    v_lshlrev_b32 v74, 16, v13
    v_and_b32 v75, s38, v13
    v_lshlrev_b32 v76, 16, v14
    v_and_b32 v77, s38, v14
    v_lshlrev_b32 v78, 16, v15
    v_and_b32 v79, s38, v15
    v_lshlrev_b32 v80, 16, v16
    v_and_b32 v81, s38, v16
    v_lshlrev_b32 v82, 16, v17
    v_and_b32 v83, s38, v17
    v_lshlrev_b32 v84, 16, v18
    v_and_b32 v85, s38, v18
    v_lshlrev_b32 v86, 16, v19
    v_and_b32 v87, s38, v19
    v_lshlrev_b32 v88, 16, v20
    v_and_b32 v89, s38, v20
    v_lshlrev_b32 v90, 16, v21
    v_and_b32 v91, s38, v21
    v_lshlrev_b32 v92, 16, v22
    v_and_b32 v93, s38, v22
    v_lshlrev_b32 v94, 16, v23
    v_and_b32 v95, s38, v23
    v_lshlrev_b32 v96, 16, v24
    v_and_b32 v97, s38, v24
    v_lshlrev_b32 v98, 16, v25
    v_and_b32 v99, s38, v25
    v_lshlrev_b32 v100, 16, v26
    v_and_b32 v101, s38, v26
    v_lshlrev_b32 v102, 16, v27
    v_and_b32 v103, s38, v27
    v_lshlrev_b32 v104, 16, v28
    v_and_b32 v105, s38, v28
    v_lshlrev_b32 v106, 16, v29
    v_and_b32 v107, s38, v29
    v_lshlrev_b32 v108, 16, v30
    v_and_b32 v109, s38, v30
    v_lshlrev_b32 v110, 16, v31
    v_and_b32 v111, s38, v31
    v_mov_b32 v112, v64
    v_mov_b32 v113, v65
    v_mov_b32 v114, v66
    v_mov_b32 v115, v67
    v_mov_b32 v116, v68
    v_mov_b32 v117, v69
    v_mov_b32 v118, v70
    v_mov_b32 v119, v71
    v_mov_b32 v120, v72
    v_mov_b32 v121, v73
    v_mov_b32 v122, v74
    v_mov_b32 v123, v75
    v_mov_b32 v124, v76
    v_mov_b32 v125, v77
    v_mov_b32 v126, v78
    v_mov_b32 v127, v79
    v_mov_b32 v128, v80
    v_mov_b32 v129, v81
    v_mov_b32 v130, v82
    v_mov_b32 v131, v83
    v_mov_b32 v132, v84
    v_mov_b32 v133, v85
    v_mov_b32 v134, v86
    v_mov_b32 v135, v87
    v_mov_b32 v136, v88
    v_mov_b32 v137, v89
    v_mov_b32 v138, v90
    v_mov_b32 v139, v91
    v_mov_b32 v140, v92
    v_mov_b32 v141, v93
    v_mov_b32 v142, v94
    v_mov_b32 v143, v95
    v_mov_b32 v144, v96
    v_mov_b32 v145, v97
    v_mov_b32 v146, v98
    v_mov_b32 v147, v99
    v_mov_b32 v148, v100
    v_mov_b32 v149, v101
    v_mov_b32 v150, v102
    v_mov_b32 v151, v103
    v_mov_b32 v152, v104
    v_mov_b32 v153, v105
    v_mov_b32 v154, v106
    v_mov_b32 v155, v107
    v_mov_b32 v156, v108
    v_mov_b32 v157, v109
    v_mov_b32 v158, v110
    v_mov_b32 v159, v111
    v_mov_b32 v160, v64
    v_mov_b32 v161, v65
    v_mov_b32 v162, v66
    v_mov_b32 v163, v67
    v_mov_b32 v164, v68
    v_mov_b32 v165, v69
    v_mov_b32 v166, v70
    v_mov_b32 v167, v71
    v_mov_b32 v168, v72
    v_mov_b32 v169, v73
    v_mov_b32 v170, v74
    v_mov_b32 v171, v75
    v_mov_b32 v172, v76
    v_mov_b32 v173, v77
    v_mov_b32 v174, v78
    v_mov_b32 v175, v79
    v_mov_b32 v176, v80
    v_mov_b32 v177, v81
    v_mov_b32 v178, v82
    v_mov_b32 v179, v83
    v_mov_b32 v180, v84
    v_mov_b32 v181, v85
    v_mov_b32 v182, v86
    v_mov_b32 v183, v87
    v_mov_b32 v184, v88
    v_mov_b32 v185, v89
    v_mov_b32 v186, v90
    v_mov_b32 v187, v91
    v_mov_b32 v188, v92
    v_mov_b32 v189, v93
    v_mov_b32 v190, v94
    v_mov_b32 v191, v95
    v_mov_b32 v192, v96
    v_mov_b32 v193, v97
    v_mov_b32 v194, v98
    v_mov_b32 v195, v99
    v_mov_b32 v196, v100
    v_mov_b32 v197, v101
    v_mov_b32 v198, v102
    v_mov_b32 v199, v103
    v_mov_b32 v200, v104
    v_mov_b32 v201, v105
    v_mov_b32 v202, v106
    v_mov_b32 v203, v107
    v_mov_b32 v204, v108
    v_mov_b32 v205, v109
    v_mov_b32 v206, v110
    v_mov_b32 v207, v111
    v_mov_b32 v208, v64
    v_mov_b32 v209, v65
    v_mov_b32 v210, v66
    v_mov_b32 v211, v67
    v_mov_b32 v212, v68
    v_mov_b32 v213, v69
    v_mov_b32 v214, v70
    v_mov_b32 v215, v71
    v_mov_b32 v216, v72
    v_mov_b32 v217, v73
    v_mov_b32 v218, v74
    v_mov_b32 v219, v75
    v_mov_b32 v220, v76
    v_mov_b32 v221, v77
    v_mov_b32 v222, v78
    v_mov_b32 v223, v79
    v_mov_b32 v224, v80
    v_mov_b32 v225, v81
    v_mov_b32 v226, v82
    v_mov_b32 v227, v83
    v_mov_b32 v228, v84
    v_mov_b32 v229, v85
    v_mov_b32 v230, v86
    v_mov_b32 v231, v87
    v_mov_b32 v232, v88
    v_mov_b32 v233, v89
    v_mov_b32 v234, v90
    v_mov_b32 v235, v91
    v_mov_b32 v236, v92
    v_mov_b32 v237, v93
    v_mov_b32 v238, v94
    v_mov_b32 v239, v95
    v_mov_b32 v240, v96
    v_mov_b32 v241, v97
    v_mov_b32 v242, v98
    v_mov_b32 v243, v99
    v_mov_b32 v244, v100
    v_mov_b32 v245, v101
    v_mov_b32 v246, v102
    v_mov_b32 v247, v103
    v_mov_b32 v248, v104
    v_mov_b32 v249, v105
    v_mov_b32 v250, v106
    v_mov_b32 v251, v107
    v_mov_b32 v252, v108
    v_mov_b32 v253, v109
    v_mov_b32 v254, v110
    v_mov_b32 v255, v111
    s_mov_b32 s40, 0
    s_mov_b32 s43, 0
    s_mov_b32 s41, 9
    s_barrier
    ds_read_b64_tr_b16 v[24:25], v52 offset:0
    ds_read_b64_tr_b16 v[26:27], v52 offset:1536
    ds_read_b128 v[8:11], v48 offset:0
    ds_read_b64_tr_b16 v[28:29], v53 offset:64
    ds_read_b64_tr_b16 v[30:31], v53 offset:1600
    ds_read_b128 v[12:15], v48 offset:4096
    ds_read_b64_tr_b16 v[32:33], v52 offset:128
    ds_read_b64_tr_b16 v[34:35], v52 offset:1664
    ds_read_b128 v[16:19], v48 offset:8192
L_k1_nn_cloop:
    s_waitcnt lgkmcnt(1)
    v_mfma_f32_32x32x16_bf16 v[64:79], v[24:27], v[8:11], v[64:79]
    ds_read_b128 v[20:23], v48 offset:12288
    v_mfma_f32_32x32x16_bf16 v[80:95], v[28:31], v[8:11], v[80:95]
    ds_read_b64_tr_b16 v[36:37], v52 offset:6144
    v_mfma_f32_32x32x16_bf16 v[96:111], v[32:35], v[8:11], v[96:111]
    ds_read_b64_tr_b16 v[38:39], v52 offset:7680
    v_mfma_f32_32x32x16_bf16 v[112:127], v[24:27], v[12:15], v[112:127]
    ds_read_b128 v[8:11], v49 offset:0
    v_mfma_f32_32x32x16_bf16 v[128:143], v[28:31], v[12:15], v[128:143]
    ds_read_b64_tr_b16 v[40:41], v53 offset:6208
    v_mfma_f32_32x32x16_bf16 v[144:159], v[32:35], v[12:15], v[144:159]
    ds_read_b64_tr_b16 v[42:43], v53 offset:7744
    s_waitcnt lgkmcnt(6)
    v_mfma_f32_32x32x16_bf16 v[160:175], v[24:27], v[16:19], v[160:175]
    ds_read_b128 v[12:15], v49 offset:4096
    v_mfma_f32_32x32x16_bf16 v[176:191], v[28:31], v[16:19], v[176:191]
    ds_read_b64_tr_b16 v[44:45], v52 offset:6272
    v_mfma_f32_32x32x16_bf16 v[192:207], v[32:35], v[16:19], v[192:207]
    ds_read_b64_tr_b16 v[46:47], v52 offset:7808
    s_waitcnt lgkmcnt(8)
    v_mfma_f32_32x32x16_bf16 v[208:223], v[24:27], v[20:23], v[208:223]
    ds_read_b128 v[16:19], v49 offset:8192
    v_mfma_f32_32x32x16_bf16 v[224:239], v[28:31], v[20:23], v[224:239]
    v_mfma_f32_32x32x16_bf16 v[240:255], v[32:35], v[20:23], v[240:255]
    s_add_u32 s40, s40, 1
    s_cmp_eq_u32 s40, 5
    s_mov_b32 s42, 12288
    s_cselect_b32 s42, -49152, s42
    s_cselect_b32 s40, 0, s40
    v_add_u32 v52, s42, v52
    v_add_u32 v53, s42, v53
    s_waitcnt lgkmcnt(1)
    v_mfma_f32_32x32x16_bf16 v[64:79], v[36:39], v[8:11], v[64:79]
    ds_read_b128 v[20:23], v49 offset:12288
    v_mfma_f32_32x32x16_bf16 v[80:95], v[40:43], v[8:11], v[80:95]
    ds_read_b64_tr_b16 v[24:25], v52 offset:0
    v_mfma_f32_32x32x16_bf16 v[96:111], v[44:47], v[8:11], v[96:111]
    ds_read_b64_tr_b16 v[26:27], v52 offset:1536
    v_mfma_f32_32x32x16_bf16 v[112:127], v[36:39], v[12:15], v[112:127]
    ds_read_b128 v[8:11], v50 offset:0
    v_mfma_f32_32x32x16_bf16 v[128:143], v[40:43], v[12:15], v[128:143]
    ds_read_b64_tr_b16 v[28:29], v53 offset:64
    v_mfma_f32_32x32x16_bf16 v[144:159], v[44:47], v[12:15], v[144:159]
    ds_read_b64_tr_b16 v[30:31], v53 offset:1600
    s_waitcnt lgkmcnt(6)
    v_mfma_f32_32x32x16_bf16 v[160:175], v[36:39], v[16:19], v[160:175]
    ds_read_b128 v[12:15], v50 offset:4096
    v_mfma_f32_32x32x16_bf16 v[176:191], v[40:43], v[16:19], v[176:191]
    ds_read_b64_tr_b16 v[32:33], v52 offset:128
    v_mfma_f32_32x32x16_bf16 v[192:207], v[44:47], v[16:19], v[192:207]
    ds_read_b64_tr_b16 v[34:35], v52 offset:1664
    s_waitcnt lgkmcnt(8)
    v_mfma_f32_32x32x16_bf16 v[208:223], v[36:39], v[20:23], v[208:223]
    ds_read_b128 v[16:19], v50 offset:8192
    v_mfma_f32_32x32x16_bf16 v[224:239], v[40:43], v[20:23], v[224:239]
    v_mfma_f32_32x32x16_bf16 v[240:255], v[44:47], v[20:23], v[240:255]
    s_barrier
    s_waitcnt lgkmcnt(1)
    v_mfma_f32_32x32x16_bf16 v[64:79], v[24:27], v[8:11], v[64:79]
    ds_read_b128 v[20:23], v50 offset:12288
    v_mfma_f32_32x32x16_bf16 v[80:95], v[28:31], v[8:11], v[80:95]
    ds_read_b64_tr_b16 v[36:37], v52 offset:6144
    v_mfma_f32_32x32x16_bf16 v[96:111], v[32:35], v[8:11], v[96:111]
    ds_read_b64_tr_b16 v[38:39], v52 offset:7680
    v_mfma_f32_32x32x16_bf16 v[112:127], v[24:27], v[12:15], v[112:127]
    ds_read_b128 v[8:11], v51 offset:0
    v_mfma_f32_32x32x16_bf16 v[128:143], v[28:31], v[12:15], v[128:143]
    ds_read_b64_tr_b16 v[40:41], v53 offset:6208
    v_mfma_f32_32x32x16_bf16 v[144:159], v[32:35], v[12:15], v[144:159]
    ds_read_b64_tr_b16 v[42:43], v53 offset:7744
    s_waitcnt lgkmcnt(6)
    v_mfma_f32_32x32x16_bf16 v[160:175], v[24:27], v[16:19], v[160:175]
    ds_read_b128 v[12:15], v51 offset:4096
    v_mfma_f32_32x32x16_bf16 v[176:191], v[28:31], v[16:19], v[176:191]
    ds_read_b64_tr_b16 v[44:45], v52 offset:6272
    v_mfma_f32_32x32x16_bf16 v[192:207], v[32:35], v[16:19], v[192:207]
    ds_read_b64_tr_b16 v[46:47], v52 offset:7808
    s_waitcnt lgkmcnt(8)
    v_mfma_f32_32x32x16_bf16 v[208:223], v[24:27], v[20:23], v[208:223]
    ds_read_b128 v[16:19], v51 offset:8192
    v_mfma_f32_32x32x16_bf16 v[224:239], v[28:31], v[20:23], v[224:239]
    v_mfma_f32_32x32x16_bf16 v[240:255], v[32:35], v[20:23], v[240:255]
    s_add_u32 s40, s40, 1
    s_cmp_eq_u32 s40, 5
    s_mov_b32 s42, 12288
    s_cselect_b32 s42, -49152, s42
    s_cselect_b32 s40, 0, s40
    v_add_u32 v52, s42, v52
    v_add_u32 v53, s42, v53
    s_add_u32 s43, s43, 1
    s_cmp_eq_u32 s43, 3
    s_mov_b32 s45, 32768
    s_cselect_b32 s45, -65536, s45
    s_cselect_b32 s43, 0, s43
    v_add_u32 v48, s45, v48
    v_add_u32 v49, s45, v49
    v_add_u32 v50, s45, v50
    s_waitcnt lgkmcnt(1)
    v_mfma_f32_32x32x16_bf16 v[64:79], v[36:39], v[8:11], v[64:79]
    ds_read_b128 v[20:23], v51 offset:12288
    v_add_u32 v51, s45, v51
    v_mfma_f32_32x32x16_bf16 v[80:95], v[40:43], v[8:11], v[80:95]
    ds_read_b64_tr_b16 v[24:25], v52 offset:0
    v_mfma_f32_32x32x16_bf16 v[96:111], v[44:47], v[8:11], v[96:111]
    ds_read_b64_tr_b16 v[26:27], v52 offset:1536
    v_mfma_f32_32x32x16_bf16 v[112:127], v[36:39], v[12:15], v[112:127]
    ds_read_b128 v[8:11], v48 offset:0
    v_mfma_f32_32x32x16_bf16 v[128:143], v[40:43], v[12:15], v[128:143]
    ds_read_b64_tr_b16 v[28:29], v53 offset:64
    v_mfma_f32_32x32x16_bf16 v[144:159], v[44:47], v[12:15], v[144:159]
    ds_read_b64_tr_b16 v[30:31], v53 offset:1600
    s_waitcnt lgkmcnt(6)
    v_mfma_f32_32x32x16_bf16 v[160:175], v[36:39], v[16:19], v[160:175]
    ds_read_b128 v[12:15], v48 offset:4096
    v_mfma_f32_32x32x16_bf16 v[176:191], v[40:43], v[16:19], v[176:191]
    ds_read_b64_tr_b16 v[32:33], v52 offset:128
    v_mfma_f32_32x32x16_bf16 v[192:207], v[44:47], v[16:19], v[192:207]
    ds_read_b64_tr_b16 v[34:35], v52 offset:1664
    s_waitcnt lgkmcnt(8)
    v_mfma_f32_32x32x16_bf16 v[208:223], v[36:39], v[20:23], v[208:223]
    ds_read_b128 v[16:19], v48 offset:8192
    v_mfma_f32_32x32x16_bf16 v[224:239], v[40:43], v[20:23], v[224:239]
    v_mfma_f32_32x32x16_bf16 v[240:255], v[44:47], v[20:23], v[240:255]
    s_sub_u32 s41, s41, 1
    s_cmp_lg_u32 s41, 0
    s_barrier
    s_cbranch_scc1 L_k1_nn_cloop
    s_waitcnt lgkmcnt(0)
    s_nop 15
    v_and_b32 v3, 31, v2
    v_lshrrev_b32 v4, 5, v2
    s_lshl_b32 s38, s36, 7
    v_add_u32 v3, s38, v3
    v_mul_u32_u24 v3, 400, v3
    v_lshl_add_u32 v3, v4, 3, v3
    s_mul_i32 s38, s37, 192
    v_add_u32 v3, s38, v3
    v_cvt_pk_bf16_f32 v8, v64, v65
    v_cvt_pk_bf16_f32 v9, v66, v67
    ds_write_b64 v3, v[8:9] offset:0
    v_cvt_pk_bf16_f32 v10, v68, v69
    v_cvt_pk_bf16_f32 v11, v70, v71
    ds_write_b64 v3, v[10:11] offset:16
    v_cvt_pk_bf16_f32 v12, v72, v73
    v_cvt_pk_bf16_f32 v13, v74, v75
    ds_write_b64 v3, v[12:13] offset:32
    v_cvt_pk_bf16_f32 v14, v76, v77
    v_cvt_pk_bf16_f32 v15, v78, v79
    ds_write_b64 v3, v[14:15] offset:48
    v_cvt_pk_bf16_f32 v16, v80, v81
    v_cvt_pk_bf16_f32 v17, v82, v83
    ds_write_b64 v3, v[16:17] offset:64
    v_cvt_pk_bf16_f32 v18, v84, v85
    v_cvt_pk_bf16_f32 v19, v86, v87
    ds_write_b64 v3, v[18:19] offset:80
    v_cvt_pk_bf16_f32 v20, v88, v89
    v_cvt_pk_bf16_f32 v21, v90, v91
    ds_write_b64 v3, v[20:21] offset:96
    v_cvt_pk_bf16_f32 v22, v92, v93
    v_cvt_pk_bf16_f32 v23, v94, v95
    ds_write_b64 v3, v[22:23] offset:112
    v_cvt_pk_bf16_f32 v24, v96, v97
    v_cvt_pk_bf16_f32 v25, v98, v99
    ds_write_b64 v3, v[24:25] offset:128
    v_cvt_pk_bf16_f32 v26, v100, v101
    v_cvt_pk_bf16_f32 v27, v102, v103
    ds_write_b64 v3, v[26:27] offset:144
    v_cvt_pk_bf16_f32 v28, v104, v105
    v_cvt_pk_bf16_f32 v29, v106, v107
    ds_write_b64 v3, v[28:29] offset:160
    v_cvt_pk_bf16_f32 v30, v108, v109
    v_cvt_pk_bf16_f32 v31, v110, v111
    ds_write_b64 v3, v[30:31] offset:176
    v_cvt_pk_bf16_f32 v32, v112, v113
    v_cvt_pk_bf16_f32 v33, v114, v115
    ds_write_b64 v3, v[32:33] offset:12800
    v_cvt_pk_bf16_f32 v34, v116, v117
    v_cvt_pk_bf16_f32 v35, v118, v119
    ds_write_b64 v3, v[34:35] offset:12816
    v_cvt_pk_bf16_f32 v36, v120, v121
    v_cvt_pk_bf16_f32 v37, v122, v123
    ds_write_b64 v3, v[36:37] offset:12832
    v_cvt_pk_bf16_f32 v38, v124, v125
    v_cvt_pk_bf16_f32 v39, v126, v127
    ds_write_b64 v3, v[38:39] offset:12848
    v_cvt_pk_bf16_f32 v8, v128, v129
    v_cvt_pk_bf16_f32 v9, v130, v131
    ds_write_b64 v3, v[8:9] offset:12864
    v_cvt_pk_bf16_f32 v10, v132, v133
    v_cvt_pk_bf16_f32 v11, v134, v135
    ds_write_b64 v3, v[10:11] offset:12880
    v_cvt_pk_bf16_f32 v12, v136, v137
    v_cvt_pk_bf16_f32 v13, v138, v139
    ds_write_b64 v3, v[12:13] offset:12896
    v_cvt_pk_bf16_f32 v14, v140, v141
    v_cvt_pk_bf16_f32 v15, v142, v143
    ds_write_b64 v3, v[14:15] offset:12912
    v_cvt_pk_bf16_f32 v16, v144, v145
    v_cvt_pk_bf16_f32 v17, v146, v147
    ds_write_b64 v3, v[16:17] offset:12928
    v_cvt_pk_bf16_f32 v18, v148, v149
    v_cvt_pk_bf16_f32 v19, v150, v151
    ds_write_b64 v3, v[18:19] offset:12944
    v_cvt_pk_bf16_f32 v20, v152, v153
    v_cvt_pk_bf16_f32 v21, v154, v155
    ds_write_b64 v3, v[20:21] offset:12960
    v_cvt_pk_bf16_f32 v22, v156, v157
    v_cvt_pk_bf16_f32 v23, v158, v159
    ds_write_b64 v3, v[22:23] offset:12976
    v_cvt_pk_bf16_f32 v24, v160, v161
    v_cvt_pk_bf16_f32 v25, v162, v163
    ds_write_b64 v3, v[24:25] offset:25600
    v_cvt_pk_bf16_f32 v26, v164, v165
    v_cvt_pk_bf16_f32 v27, v166, v167
    ds_write_b64 v3, v[26:27] offset:25616
    v_cvt_pk_bf16_f32 v28, v168, v169
    v_cvt_pk_bf16_f32 v29, v170, v171
    ds_write_b64 v3, v[28:29] offset:25632
    v_cvt_pk_bf16_f32 v30, v172, v173
    v_cvt_pk_bf16_f32 v31, v174, v175
    ds_write_b64 v3, v[30:31] offset:25648
    v_cvt_pk_bf16_f32 v32, v176, v177
    v_cvt_pk_bf16_f32 v33, v178, v179
    ds_write_b64 v3, v[32:33] offset:25664
    v_cvt_pk_bf16_f32 v34, v180, v181
    v_cvt_pk_bf16_f32 v35, v182, v183
    ds_write_b64 v3, v[34:35] offset:25680
    v_cvt_pk_bf16_f32 v36, v184, v185
    v_cvt_pk_bf16_f32 v37, v186, v187
    ds_write_b64 v3, v[36:37] offset:25696
    v_cvt_pk_bf16_f32 v38, v188, v189
    v_cvt_pk_bf16_f32 v39, v190, v191
    ds_write_b64 v3, v[38:39] offset:25712
    v_cvt_pk_bf16_f32 v8, v192, v193
    v_cvt_pk_bf16_f32 v9, v194, v195
    ds_write_b64 v3, v[8:9] offset:25728
    v_cvt_pk_bf16_f32 v10, v196, v197
    v_cvt_pk_bf16_f32 v11, v198, v199
    ds_write_b64 v3, v[10:11] offset:25744
    v_cvt_pk_bf16_f32 v12, v200, v201
    v_cvt_pk_bf16_f32 v13, v202, v203
    ds_write_b64 v3, v[12:13] offset:25760
    v_cvt_pk_bf16_f32 v14, v204, v205
    v_cvt_pk_bf16_f32 v15, v206, v207
    ds_write_b64 v3, v[14:15] offset:25776
    v_cvt_pk_bf16_f32 v16, v208, v209
    v_cvt_pk_bf16_f32 v17, v210, v211
    ds_write_b64 v3, v[16:17] offset:38400
    v_cvt_pk_bf16_f32 v18, v212, v213
    v_cvt_pk_bf16_f32 v19, v214, v215
    ds_write_b64 v3, v[18:19] offset:38416
    v_cvt_pk_bf16_f32 v20, v216, v217
    v_cvt_pk_bf16_f32 v21, v218, v219
    ds_write_b64 v3, v[20:21] offset:38432
    v_cvt_pk_bf16_f32 v22, v220, v221
    v_cvt_pk_bf16_f32 v23, v222, v223
    ds_write_b64 v3, v[22:23] offset:38448
    v_cvt_pk_bf16_f32 v24, v224, v225
    v_cvt_pk_bf16_f32 v25, v226, v227
    ds_write_b64 v3, v[24:25] offset:38464
    v_cvt_pk_bf16_f32 v26, v228, v229
    v_cvt_pk_bf16_f32 v27, v230, v231
    ds_write_b64 v3, v[26:27] offset:38480
    v_cvt_pk_bf16_f32 v28, v232, v233
    v_cvt_pk_bf16_f32 v29, v234, v235
    ds_write_b64 v3, v[28:29] offset:38496
    v_cvt_pk_bf16_f32 v30, v236, v237
    v_cvt_pk_bf16_f32 v31, v238, v239
    ds_write_b64 v3, v[30:31] offset:38512
    v_cvt_pk_bf16_f32 v32, v240, v241
    v_cvt_pk_bf16_f32 v33, v242, v243
    ds_write_b64 v3, v[32:33] offset:38528
    v_cvt_pk_bf16_f32 v34, v244, v245
    v_cvt_pk_bf16_f32 v35, v246, v247
    ds_write_b64 v3, v[34:35] offset:38544
    v_cvt_pk_bf16_f32 v36, v248, v249
    v_cvt_pk_bf16_f32 v37, v250, v251
    ds_write_b64 v3, v[36:37] offset:38560
    v_cvt_pk_bf16_f32 v38, v252, v253
    v_cvt_pk_bf16_f32 v39, v254, v255
    ds_write_b64 v3, v[38:39] offset:38576
    s_waitcnt lgkmcnt(0)
    s_branch L_k1_nn_epi
L_k1_nn_loader:
    s_sub_u32 s36, s32, 4
    v_lshrrev_b32 v3, 3, v2
    v_and_b32 v4, 7, v2
    v_lshrrev_b32 v5, 4, v2
    v_xor_b32 v4, v4, v5
    s_lshl_b32 s37, s36, 6
    s_add_u32 s37, s37, s33
    v_add_u32 v5, s37, v3
    v_mul_u32_u24 v5, 1152, v5
    v_lshl_add_u32 v8, v4, 4, v5
    v_xor_b32 v4, 4, v4
    v_lshl_add_u32 v9, v4, 4, v5
    v_add_u32 v3, 0, v2
    v_mul_u32_u24 v4, 2731, v3
    v_lshrrev_b32 v4, 16, v4
    v_mul_u32_u24 v5, 24, v4
    v_sub_u32 v5, v3, v5
    v_bfe_u32 v6, v4, 1, 1
    v_lshlrev_b32 v6, 2, v6
    v_xor_b32 v5, v5, v6
    s_lshl_b32 s37, s36, 3
    v_add_u32 v4, s37, v4
    s_mov_b32 s37, 9216
    v_mul_lo_u32 v4, v4, s37
    v_lshl_add_u32 v4, v5, 4, v4
    s_lshl_b32 s37, s34, 1
    v_add_u32 v10, s37, v4
    v_add_u32 v3, 64, v2
    v_mul_u32_u24 v4, 2731, v3
    v_lshrrev_b32 v4, 16, v4
    v_mul_u32_u24 v5, 24, v4
    v_sub_u32 v5, v3, v5
    v_bfe_u32 v6, v4, 1, 1
    v_lshlrev_b32 v6, 2, v6
    v_xor_b32 v5, v5, v6
    s_lshl_b32 s37, s36, 3
    v_add_u32 v4, s37, v4
    s_mov_b32 s37, 9216
    v_mul_lo_u32 v4, v4, s37
    v_lshl_add_u32 v4, v5, 4, v4
    s_lshl_b32 s37, s34, 1
    v_add_u32 v11, s37, v4
    v_add_u32 v3, 128, v2
    v_mul_u32_u24 v4, 2731, v3
    v_lshrrev_b32 v4, 16, v4
    v_mul_u32_u24 v5, 24, v4
    v_sub_u32 v5, v3, v5
    v_bfe_u32 v6, v4, 1, 1
    v_lshlrev_b32 v6, 2, v6
    v_xor_b32 v5, v5, v6
    s_lshl_b32 s37, s36, 3
    v_add_u32 v4, s37, v4
    s_mov_b32 s37, 9216
    v_mul_lo_u32 v4, v4, s37
    v_lshl_add_u32 v4, v5, 4, v4
    s_lshl_b32 s37, s34, 1
    v_add_u32 v12, s37, v4
    s_lshl_b32 s38, s36, 13
    s_mul_i32 s39, s36, 3072
    s_add_u32 s39, s39, 98304
    s_mov_b32 s40, 0
    s_mov_b32 s46, 0
    s_mov_b32 s43, 0
    s_mov_b32 s44, 0
    s_add_u32 m0, s38, 0
    s_add_u32 s45, s43, 0
    buffer_load_dwordx4 v8, s[16:19], s45 offen lds
    s_add_u32 m0, s38, 1024
    s_add_u32 s45, s43, 9216
    buffer_load_dwordx4 v9, s[16:19], s45 offen lds
    s_add_u32 m0, s38, 2048
    s_add_u32 s45, s43, 18432
    buffer_load_dwordx4 v8, s[16:19], s45 offen lds
    s_add_u32 m0, s38, 3072
    s_add_u32 s45, s43, 27648
    buffer_load_dwordx4 v9, s[16:19], s45 offen lds
    s_add_u32 m0, s38, 4096
    s_add_u32 s45, s43, 36864
    buffer_load_dwordx4 v8, s[16:19], s45 offen lds
    s_add_u32 m0, s38, 5120
    s_add_u32 s45, s43, 46080
    buffer_load_dwordx4 v9, s[16:19], s45 offen lds
    s_add_u32 m0, s38, 6144
    s_add_u32 s45, s43, 55296
    buffer_load_dwordx4 v8, s[16:19], s45 offen lds
    s_add_u32 m0, s38, 7168
    s_add_u32 s45, s43, 64512
    buffer_load_dwordx4 v9, s[16:19], s45 offen lds
    s_add_u32 s43, s43, 128
    s_add_u32 s46, s46, 1
    s_cmp_eq_u32 s46, 3
    s_mov_b32 s42, 32768
    s_cselect_b32 s42, -65536, s42
    s_cselect_b32 s46, 0, s46
    s_add_u32 s38, s38, s42
    s_add_u32 m0, s39, 0
    s_nop 0
    buffer_load_dwordx4 v10, s[20:23], s44 offen lds
    s_add_u32 m0, s39, 1024
    s_nop 0
    buffer_load_dwordx4 v11, s[20:23], s44 offen lds
    s_add_u32 m0, s39, 2048
    s_nop 0
    buffer_load_dwordx4 v12, s[20:23], s44 offen lds
    s_add_u32 s44, s44, 294912
    s_add_u32 s40, s40, 1
    s_cmp_eq_u32 s40, 5
    s_mov_b32 s42, 12288
    s_cselect_b32 s42, -49152, s42
    s_cselect_b32 s40, 0, s40
    s_add_u32 s39, s39, s42
    s_add_u32 m0, s39, 0
    s_nop 0
    buffer_load_dwordx4 v10, s[20:23], s44 offen lds
    s_add_u32 m0, s39, 1024
    s_nop 0
    buffer_load_dwordx4 v11, s[20:23], s44 offen lds
    s_add_u32 m0, s39, 2048
    s_nop 0
    buffer_load_dwordx4 v12, s[20:23], s44 offen lds
    s_add_u32 s44, s44, 294912
    s_add_u32 s40, s40, 1
    s_cmp_eq_u32 s40, 5
    s_mov_b32 s42, 12288
    s_cselect_b32 s42, -49152, s42
    s_cselect_b32 s40, 0, s40
    s_add_u32 s39, s39, s42
    s_add_u32 m0, s38, 0
    s_add_u32 s45, s43, 0
    buffer_load_dwordx4 v8, s[16:19], s45 offen lds
    s_add_u32 m0, s38, 1024
    s_add_u32 s45, s43, 9216
    buffer_load_dwordx4 v9, s[16:19], s45 offen lds
    s_add_u32 m0, s38, 2048
    s_add_u32 s45, s43, 18432
    buffer_load_dwordx4 v8, s[16:19], s45 offen lds
    s_add_u32 m0, s38, 3072
    s_add_u32 s45, s43, 27648
    buffer_load_dwordx4 v9, s[16:19], s45 offen lds
    s_add_u32 m0, s38, 4096
    s_add_u32 s45, s43, 36864
    buffer_load_dwordx4 v8, s[16:19], s45 offen lds
    s_add_u32 m0, s38, 5120
    s_add_u32 s45, s43, 46080
    buffer_load_dwordx4 v9, s[16:19], s45 offen lds
    s_add_u32 m0, s38, 6144
    s_add_u32 s45, s43, 55296
    buffer_load_dwordx4 v8, s[16:19], s45 offen lds
    s_add_u32 m0, s38, 7168
    s_add_u32 s45, s43, 64512
    buffer_load_dwordx4 v9, s[16:19], s45 offen lds
    s_add_u32 s43, s43, 128
    s_add_u32 s46, s46, 1
    s_cmp_eq_u32 s46, 3
    s_mov_b32 s42, 32768
    s_cselect_b32 s42, -65536, s42
    s_cselect_b32 s46, 0, s46
    s_add_u32 s38, s38, s42
    s_add_u32 m0, s39, 0
    s_nop 0
    buffer_load_dwordx4 v10, s[20:23], s44 offen lds
    s_add_u32 m0, s39, 1024
    s_nop 0
    buffer_load_dwordx4 v11, s[20:23], s44 offen lds
    s_add_u32 m0, s39, 2048
    s_nop 0
    buffer_load_dwordx4 v12, s[20:23], s44 offen lds
    s_add_u32 s44, s44, 294912
    s_add_u32 s40, s40, 1
    s_cmp_eq_u32 s40, 5
    s_mov_b32 s42, 12288
    s_cselect_b32 s42, -49152, s42
    s_cselect_b32 s40, 0, s40
    s_add_u32 s39, s39, s42
    s_add_u32 m0, s39, 0
    s_nop 0
    buffer_load_dwordx4 v10, s[20:23], s44 offen lds
    s_add_u32 m0, s39, 1024
    s_nop 0
    buffer_load_dwordx4 v11, s[20:23], s44 offen lds
    s_add_u32 m0, s39, 2048
    s_nop 0
    buffer_load_dwordx4 v12, s[20:23], s44 offen lds
    s_add_u32 s44, s44, 294912
    s_add_u32 s40, s40, 1
    s_cmp_eq_u32 s40, 5
    s_mov_b32 s42, 12288
    s_cselect_b32 s42, -49152, s42
    s_cselect_b32 s40, 0, s40
    s_add_u32 s39, s39, s42
    s_waitcnt vmcnt(14)
    s_barrier
    s_mov_b32 s41, 7
L_k1_nn_lloop:
    s_add_u32 m0, s39, 0
    s_nop 0
    buffer_load_dwordx4 v10, s[20:23], s44 offen lds
    s_add_u32 m0, s39, 1024
    s_nop 0
    buffer_load_dwordx4 v11, s[20:23], s44 offen lds
    s_add_u32 m0, s39, 2048
    s_nop 0
    buffer_load_dwordx4 v12, s[20:23], s44 offen lds
    s_add_u32 s44, s44, 294912
    s_add_u32 s40, s40, 1
    s_cmp_eq_u32 s40, 5
    s_mov_b32 s42, 12288
    s_cselect_b32 s42, -49152, s42
    s_cselect_b32 s40, 0, s40
    s_add_u32 s39, s39, s42
    s_add_u32 m0, s38, 0
    s_add_u32 s45, s43, 0
    buffer_load_dwordx4 v8, s[16:19], s45 offen lds
    s_add_u32 m0, s38, 1024
    s_add_u32 s45, s43, 9216
    buffer_load_dwordx4 v9, s[16:19], s45 offen lds
    s_add_u32 m0, s38, 2048
    s_add_u32 s45, s43, 18432
    buffer_load_dwordx4 v8, s[16:19], s45 offen lds
    s_add_u32 m0, s38, 3072
    s_add_u32 s45, s43, 27648
    buffer_load_dwordx4 v9, s[16:19], s45 offen lds
    s_add_u32 m0, s38, 4096
    s_add_u32 s45, s43, 36864
    buffer_load_dwordx4 v8, s[16:19], s45 offen lds
    s_add_u32 m0, s38, 5120
    s_add_u32 s45, s43, 46080
    buffer_load_dwordx4 v9, s[16:19], s45 offen lds
    s_add_u32 m0, s38, 6144
    s_add_u32 s45, s43, 55296
    buffer_load_dwordx4 v8, s[16:19], s45 offen lds
    s_add_u32 m0, s38, 7168
    s_add_u32 s45, s43, 64512
    buffer_load_dwordx4 v9, s[16:19], s45 offen lds
    s_add_u32 s43, s43, 128
    s_add_u32 s46, s46, 1
    s_cmp_eq_u32 s46, 3
    s_mov_b32 s42, 32768
    s_cselect_b32 s42, -65536, s42
    s_cselect_b32 s46, 0, s46
    s_add_u32 s38, s38, s42
    s_waitcnt vmcnt(14)
    s_barrier
    s_add_u32 m0, s39, 0
    s_nop 0
    buffer_load_dwordx4 v10, s[20:23], s44 offen lds
    s_add_u32 m0, s39, 1024
    s_nop 0
    buffer_load_dwordx4 v11, s[20:23], s44 offen lds
    s_add_u32 m0, s39, 2048
    s_nop 0
    buffer_load_dwordx4 v12, s[20:23], s44 offen lds
    s_add_u32 s44, s44, 294912
    s_add_u32 s40, s40, 1
    s_cmp_eq_u32 s40, 5
    s_mov_b32 s42, 12288
    s_cselect_b32 s42, -49152, s42
    s_cselect_b32 s40, 0, s40
    s_add_u32 s39, s39, s42
    s_sub_u32 s41, s41, 1
    s_cmp_lg_u32 s41, 0
    s_waitcnt vmcnt(14)
    s_barrier
    s_cbranch_scc1 L_k1_nn_lloop
    s_waitcnt vmcnt(3)
    s_barrier
    s_waitcnt vmcnt(0)
    s_barrier
    s_barrier
    s_barrier
L_k1_nn_epi:
    v_add_u32 v3, 0, v0
    v_mul_u32_u24 v4, 2731, v3
    v_lshrrev_b32 v4, 16, v4
    v_mul_u32_u24 v5, 24, v4
    v_sub_u32 v5, v3, v5
    v_mul_u32_u24 v6, 400, v4
    v_lshl_add_u32 v8, v5, 4, v6
    v_add_u32 v4, s33, v4
    s_mov_b32 s37, 9216
    v_mul_lo_u32 v4, v4, s37
    v_lshl_add_u32 v4, v5, 4, v4
    s_lshl_b32 s37, s34, 1
    v_add_u32 v11, s37, v4
    v_add_u32 v3, 512, v0
    v_mul_u32_u24 v4, 2731, v3
    v_lshrrev_b32 v4, 16, v4
    v_mul_u32_u24 v5, 24, v4
    v_sub_u32 v5, v3, v5
    v_mul_u32_u24 v6, 400, v4
    v_lshl_add_u32 v9, v5, 4, v6
    v_add_u32 v4, s33, v4
    s_mov_b32 s37, 9216
    v_mul_lo_u32 v4, v4, s37
    v_lshl_add_u32 v4, v5, 4, v4
    s_lshl_b32 s37, s34, 1
    v_add_u32 v12, s37, v4
    v_add_u32 v3, 1024, v0
    v_mul_u32_u24 v4, 2731, v3
    v_lshrrev_b32 v4, 16, v4
    v_mul_u32_u24 v5, 24, v4
    v_sub_u32 v5, v3, v5
    v_mul_u32_u24 v6, 400, v4
    v_lshl_add_u32 v10, v5, 4, v6
    v_add_u32 v4, s33, v4
    s_mov_b32 s37, 9216
    v_mul_lo_u32 v4, v4, s37
    v_lshl_add_u32 v4, v5, 4, v4
    s_lshl_b32 s37, s34, 1
    v_add_u32 v13, s37, v4
    s_mov_b32 s46, 0xffff0000
    v_mov_b32 v14, 0xc0135761
    s_mov_b32 s48, 0xbdd2d3e7
    s_barrier
    s_mov_b32 s37, 0
    s_mov_b32 s41, 4
L_k1_nn_eloop:
    ds_read_b128 v[40:43], v8
    v_add_u32 v8, 25600, v8
    ds_read_b128 v[64:67], v9
    v_add_u32 v9, 25600, v9
    ds_read_b128 v[88:91], v10
    v_add_u32 v10, 25600, v10
    s_waitcnt lgkmcnt(2)
    v_lshlrev_b32 v44, 16, v40
    v_and_b32 v45, s46, v40
    v_lshlrev_b32 v46, 16, v41
    v_and_b32 v47, s46, v41
    v_lshlrev_b32 v48, 16, v42
    v_and_b32 v49, s46, v42
    v_lshlrev_b32 v50, 16, v43
    v_and_b32 v51, s46, v43
    v_mul_f32 v52, v44, v44
    v_mul_f32 v53, v45, v45
    v_mul_f32 v54, v46, v46
    v_mul_f32 v55, v47, v47
    v_mul_f32 v56, v48, v48
    v_mul_f32 v57, v49, v49
    v_mul_f32 v58, v50, v50
    v_mul_f32 v59, v51, v51
    v_fma_f32 v52, v52, s48, v14
    v_fma_f32 v53, v53, s48, v14
    v_fma_f32 v54, v54, s48, v14
    v_fma_f32 v55, v55, s48, v14
    v_fma_f32 v56, v56, s48, v14
    v_fma_f32 v57, v57, s48, v14
    v_fma_f32 v58, v58, s48, v14
    v_fma_f32 v59, v59, s48, v14
    v_mul_f32 v52, v44, v52
    v_mul_f32 v53, v45, v53
    v_mul_f32 v54, v46, v54
    v_mul_f32 v55, v47, v55
    v_mul_f32 v56, v48, v56
    v_mul_f32 v57, v49, v57
    v_mul_f32 v58, v50, v58
    v_mul_f32 v59, v51, v59
    v_exp_f32 v52, v52
    v_exp_f32 v53, v53
    v_exp_f32 v54, v54
    v_exp_f32 v55, v55
    v_exp_f32 v56, v56
    v_exp_f32 v57, v57
    v_exp_f32 v58, v58
    v_exp_f32 v59, v59
    v_add_f32 v52, 1.0, v52
    v_add_f32 v53, 1.0, v53
    v_add_f32 v54, 1.0, v54
    v_add_f32 v55, 1.0, v55
    v_add_f32 v56, 1.0, v56
    v_add_f32 v57, 1.0, v57
    v_add_f32 v58, 1.0, v58
    v_add_f32 v59, 1.0, v59
    v_rcp_f32 v52, v52
    v_rcp_f32 v53, v53
    v_rcp_f32 v54, v54
    v_rcp_f32 v55, v55
    v_rcp_f32 v56, v56
    v_rcp_f32 v57, v57
    v_rcp_f32 v58, v58
    v_rcp_f32 v59, v59
    v_mul_f32 v44, v44, v52
    v_mul_f32 v45, v45, v53
    v_mul_f32 v46, v46, v54
    v_mul_f32 v47, v47, v55
    v_mul_f32 v48, v48, v56
    v_mul_f32 v49, v49, v57
    v_mul_f32 v50, v50, v58
    v_mul_f32 v51, v51, v59
    v_cvt_pk_bf16_f32 v40, v44, v45
    v_cvt_pk_bf16_f32 v41, v46, v47
    v_cvt_pk_bf16_f32 v42, v48, v49
    v_cvt_pk_bf16_f32 v43, v50, v51
    buffer_store_dwordx4 v[40:43], v11, s[24:27], s37 offen
    s_waitcnt lgkmcnt(1)
    v_lshlrev_b32 v68, 16, v64
    v_and_b32 v69, s46, v64
    v_lshlrev_b32 v70, 16, v65
    v_and_b32 v71, s46, v65
    v_lshlrev_b32 v72, 16, v66
    v_and_b32 v73, s46, v66
    v_lshlrev_b32 v74, 16, v67
    v_and_b32 v75, s46, v67
    v_mul_f32 v76, v68, v68
    v_mul_f32 v77, v69, v69
    v_mul_f32 v78, v70, v70
    v_mul_f32 v79, v71, v71
    v_mul_f32 v80, v72, v72
    v_mul_f32 v81, v73, v73
    v_mul_f32 v82, v74, v74
    v_mul_f32 v83, v75, v75
    v_fma_f32 v76, v76, s48, v14
    v_fma_f32 v77, v77, s48, v14
    v_fma_f32 v78, v78, s48, v14
    v_fma_f32 v79, v79, s48, v14
    v_fma_f32 v80, v80, s48, v14
    v_fma_f32 v81, v81, s48, v14
    v_fma_f32 v82, v82, s48, v14
    v_fma_f32 v83, v83, s48, v14
    v_mul_f32 v76, v68, v76
    v_mul_f32 v77, v69, v77
    v_mul_f32 v78, v70, v78
    v_mul_f32 v79, v71, v79
    v_mul_f32 v80, v72, v80
    v_mul_f32 v81, v73, v81
    v_mul_f32 v82, v74, v82
    v_mul_f32 v83, v75, v83
    v_exp_f32 v76, v76
    v_exp_f32 v77, v77
    v_exp_f32 v78, v78
    v_exp_f32 v79, v79
    v_exp_f32 v80, v80
    v_exp_f32 v81, v81
    v_exp_f32 v82, v82
    v_exp_f32 v83, v83
    v_add_f32 v76, 1.0, v76
    v_add_f32 v77, 1.0, v77
    v_add_f32 v78, 1.0, v78
    v_add_f32 v79, 1.0, v79
    v_add_f32 v80, 1.0, v80
    v_add_f32 v81, 1.0, v81
    v_add_f32 v82, 1.0, v82
    v_add_f32 v83, 1.0, v83
    v_rcp_f32 v76, v76
    v_rcp_f32 v77, v77
    v_rcp_f32 v78, v78
    v_rcp_f32 v79, v79
    v_rcp_f32 v80, v80
    v_rcp_f32 v81, v81
    v_rcp_f32 v82, v82
    v_rcp_f32 v83, v83
    v_mul_f32 v68, v68, v76
    v_mul_f32 v69, v69, v77
    v_mul_f32 v70, v70, v78
    v_mul_f32 v71, v71, v79
    v_mul_f32 v72, v72, v80
    v_mul_f32 v73, v73, v81
    v_mul_f32 v74, v74, v82
    v_mul_f32 v75, v75, v83
    v_cvt_pk_bf16_f32 v64, v68, v69
    v_cvt_pk_bf16_f32 v65, v70, v71
    v_cvt_pk_bf16_f32 v66, v72, v73
    v_cvt_pk_bf16_f32 v67, v74, v75
    buffer_store_dwordx4 v[64:67], v12, s[24:27], s37 offen
    s_waitcnt lgkmcnt(0)
    v_lshlrev_b32 v92, 16, v88
    v_and_b32 v93, s46, v88
    v_lshlrev_b32 v94, 16, v89
    v_and_b32 v95, s46, v89
    v_lshlrev_b32 v96, 16, v90
    v_and_b32 v97, s46, v90
    v_lshlrev_b32 v98, 16, v91
    v_and_b32 v99, s46, v91
    v_mul_f32 v100, v92, v92
    v_mul_f32 v101, v93, v93
    v_mul_f32 v102, v94, v94
    v_mul_f32 v103, v95, v95
    v_mul_f32 v104, v96, v96
    v_mul_f32 v105, v97, v97
    v_mul_f32 v106, v98, v98
    v_mul_f32 v107, v99, v99
    v_fma_f32 v100, v100, s48, v14
    v_fma_f32 v101, v101, s48, v14
    v_fma_f32 v102, v102, s48, v14
    v_fma_f32 v103, v103, s48, v14
    v_fma_f32 v104, v104, s48, v14
    v_fma_f32 v105, v105, s48, v14
    v_fma_f32 v106, v106, s48, v14
    v_fma_f32 v107, v107, s48, v14
    v_mul_f32 v100, v92, v100
    v_mul_f32 v101, v93, v101
    v_mul_f32 v102, v94, v102
    v_mul_f32 v103, v95, v103
    v_mul_f32 v104, v96, v104
    v_mul_f32 v105, v97, v105
    v_mul_f32 v106, v98, v106
    v_mul_f32 v107, v99, v107
    v_exp_f32 v100, v100
    v_exp_f32 v101, v101
    v_exp_f32 v102, v102
    v_exp_f32 v103, v103
    v_exp_f32 v104, v104
    v_exp_f32 v105, v105
    v_exp_f32 v106, v106
    v_exp_f32 v107, v107
    v_add_f32 v100, 1.0, v100
    v_add_f32 v101, 1.0, v101
    v_add_f32 v102, 1.0, v102
    v_add_f32 v103, 1.0, v103
    v_add_f32 v104, 1.0, v104
    v_add_f32 v105, 1.0, v105
    v_add_f32 v106, 1.0, v106
    v_add_f32 v107, 1.0, v107
    v_rcp_f32 v100, v100
    v_rcp_f32 v101, v101
    v_rcp_f32 v102, v102
    v_rcp_f32 v103, v103
    v_rcp_f32 v104, v104
    v_rcp_f32 v105, v105
    v_rcp_f32 v106, v106
    v_rcp_f32 v107, v107
    v_mul_f32 v92, v92, v100
    v_mul_f32 v93, v93, v101
    v_mul_f32 v94, v94, v102
    v_mul_f32 v95, v95, v103
    v_mul_f32 v96, v96, v104
    v_mul_f32 v97, v97, v105
    v_mul_f32 v98, v98, v106
    v_mul_f32 v99, v99, v107
    v_cvt_pk_bf16_f32 v88, v92, v93
    v_cvt_pk_bf16_f32 v89, v94, v95
    v_cvt_pk_bf16_f32 v90, v96, v97
    v_cvt_pk_bf16_f32 v91, v98, v99
    buffer_store_dwordx4 v[88:91], v13, s[24:27], s37 offen
    s_add_u32 s37, s37, 589824
    s_sub_u32 s41, s41, 1
    s_cmp_lg_u32 s41, 0
    s_cbranch_scc1 L_k1_nn_eloop
    s_endpgm
L_k1_nt:
    s_mov_b32 s16, s12
    s_mov_b32 s17, s13
    s_mov_b32 s18, 2359296
    s_mov_b32 s19, 0x00020000
    s_sub_u32 s34, s34, 24
    s_cmp_ge_u32 s34, 3
    s_cselect_b32 s20, s6, s4
    s_cselect_b32 s21, s7, s5
    s_mov_b32 s22, 663552
    s_mov_b32 s23, 0x00020000
    s_mov_b32 s35, 4718592
    s_cselect_b32 s35, 7077888, s35
    s_add_u32 s24, s12, s35
    s_addc_u32 s25, s13, 0
    s_mov_b32 s26, 2359296
    s_mov_b32 s27, 0x00020000
    s_cmp_ge_u32 s34, 3
    s_cselect_b32 s35, 3, 0
    s_sub_u32 s34, s34, s35
    s_mul_i32 s34, s34, 192
    s_cmp_ge_u32 s32, 4
    s_cbranch_scc1 L_k1_nt_loader
    s_lshr_b32 s36, s32, 1
    s_and_b32 s37, s32, 1
    v_and_b32 v3, 31, v2
    v_lshrrev_b32 v4, 5, v2
    v_bfe_u32 v5, v2, 1, 3
    v_xor_b32 v6, v4, v5
    s_lshl_b32 s38, s36, 7
    v_add_u32 v7, s38, v3
    v_lshlrev_b32 v7, 7, v7
    v_lshl_add_u32 v48, v6, 4, v7
    v_xor_b32 v49, 32, v48
    v_xor_b32 v50, 64, v48
    v_xor_b32 v51, 96, v48
    v_bfe_u32 v5, v2, 2, 2
    v_xor_b32 v6, v4, v5
    s_mul_i32 s38, s37, 96
    v_add_u32 v7, s38, v3
    v_lshlrev_b32 v7, 6, v7
    v_lshl_add_u32 v52, v6, 4, v7
    v_add_u32 v52, 98304, v52
    v_xor_b32 v53, 32, v52
    v_mov_b32 v64, 0
    v_mov_b32 v65, 0
    v_mov_b32 v66, 0
    v_mov_b32 v67, 0
    v_mov_b32 v68, 0
    v_mov_b32 v69, 0
    v_mov_b32 v70, 0
    v_mov_b32 v71, 0
    v_mov_b32 v72, 0
    v_mov_b32 v73, 0
    v_mov_b32 v74, 0
    v_mov_b32 v75, 0
    v_mov_b32 v76, 0
    v_mov_b32 v77, 0
    v_mov_b32 v78, 0
    v_mov_b32 v79, 0
    v_mov_b32 v80, 0
    v_mov_b32 v81, 0
    v_mov_b32 v82, 0
    v_mov_b32 v83, 0
    v_mov_b32 v84, 0
    v_mov_b32 v85, 0
    v_mov_b32 v86, 0
    v_mov_b32 v87, 0
    v_mov_b32 v88, 0
    v_mov_b32 v89, 0
    v_mov_b32 v90, 0
    v_mov_b32 v91, 0
    v_mov_b32 v92, 0
    v_mov_b32 v93, 0
    v_mov_b32 v94, 0
    v_mov_b32 v95, 0
    v_mov_b32 v96, 0
    v_mov_b32 v97, 0
    v_mov_b32 v98, 0
    v_mov_b32 v99, 0
    v_mov_b32 v100, 0
    v_mov_b32 v101, 0
    v_mov_b32 v102, 0
    v_mov_b32 v103, 0
    v_mov_b32 v104, 0
    v_mov_b32 v105, 0
    v_mov_b32 v106, 0
    v_mov_b32 v107, 0
    v_mov_b32 v108, 0
    v_mov_b32 v109, 0
    v_mov_b32 v110, 0
    v_mov_b32 v111, 0
    v_mov_b32 v112, 0
    v_mov_b32 v113, 0
    v_mov_b32 v114, 0
    v_mov_b32 v115, 0
    v_mov_b32 v116, 0
    v_mov_b32 v117, 0
    v_mov_b32 v118, 0
    v_mov_b32 v119, 0
    v_mov_b32 v120, 0
    v_mov_b32 v121, 0
    v_mov_b32 v122, 0
    v_mov_b32 v123, 0
    v_mov_b32 v124, 0
    v_mov_b32 v125, 0
    v_mov_b32 v126, 0
    v_mov_b32 v127, 0
    v_mov_b32 v128, 0
    v_mov_b32 v129, 0
    v_mov_b32 v130, 0
    v_mov_b32 v131, 0
    v_mov_b32 v132, 0
    v_mov_b32 v133, 0
    v_mov_b32 v134, 0
    v_mov_b32 v135, 0
    v_mov_b32 v136, 0
    v_mov_b32 v137, 0
    v_mov_b32 v138, 0
    v_mov_b32 v139, 0
    v_mov_b32 v140, 0
    v_mov_b32 v141, 0
    v_mov_b32 v142, 0
    v_mov_b32 v143, 0
    v_mov_b32 v144, 0
    v_mov_b32 v145, 0
    v_mov_b32 v146, 0
    v_mov_b32 v147, 0
    v_mov_b32 v148, 0
    v_mov_b32 v149, 0
    v_mov_b32 v150, 0
    v_mov_b32 v151, 0
    v_mov_b32 v152, 0
    v_mov_b32 v153, 0
    v_mov_b32 v154, 0
    v_mov_b32 v155, 0
    v_mov_b32 v156, 0
    v_mov_b32 v157, 0
    v_mov_b32 v158, 0
    v_mov_b32 v159, 0
    v_mov_b32 v160, 0
    v_mov_b32 v161, 0
    v_mov_b32 v162, 0
    v_mov_b32 v163, 0
    v_mov_b32 v164, 0
    v_mov_b32 v165, 0
    v_mov_b32 v166, 0
    v_mov_b32 v167, 0
    v_mov_b32 v168, 0
    v_mov_b32 v169, 0
    v_mov_b32 v170, 0
    v_mov_b32 v171, 0
    v_mov_b32 v172, 0
    v_mov_b32 v173, 0
    v_mov_b32 v174, 0
    v_mov_b32 v175, 0
    v_mov_b32 v176, 0
    v_mov_b32 v177, 0
    v_mov_b32 v178, 0
    v_mov_b32 v179, 0
    v_mov_b32 v180, 0
    v_mov_b32 v181, 0
    v_mov_b32 v182, 0
    v_mov_b32 v183, 0
    v_mov_b32 v184, 0
    v_mov_b32 v185, 0
    v_mov_b32 v186, 0
    v_mov_b32 v187, 0
    v_mov_b32 v188, 0
    v_mov_b32 v189, 0
    v_mov_b32 v190, 0
    v_mov_b32 v191, 0
    v_mov_b32 v192, 0
    v_mov_b32 v193, 0
    v_mov_b32 v194, 0
    v_mov_b32 v195, 0
    v_mov_b32 v196, 0
    v_mov_b32 v197, 0
    v_mov_b32 v198, 0
    v_mov_b32 v199, 0
    v_mov_b32 v200, 0
    v_mov_b32 v201, 0
    v_mov_b32 v202, 0
    v_mov_b32 v203, 0
    v_mov_b32 v204, 0
    v_mov_b32 v205, 0
    v_mov_b32 v206, 0
    v_mov_b32 v207, 0
    v_mov_b32 v208, 0
    v_mov_b32 v209, 0
    v_mov_b32 v210, 0
    v_mov_b32 v211, 0
    v_mov_b32 v212, 0
    v_mov_b32 v213, 0
    v_mov_b32 v214, 0
    v_mov_b32 v215, 0
    v_mov_b32 v216, 0
    v_mov_b32 v217, 0
    v_mov_b32 v218, 0
    v_mov_b32 v219, 0
    v_mov_b32 v220, 0
    v_mov_b32 v221, 0
    v_mov_b32 v222, 0
    v_mov_b32 v223, 0
    v_mov_b32 v224, 0
    v_mov_b32 v225, 0
    v_mov_b32 v226, 0
    v_mov_b32 v227, 0
    v_mov_b32 v228, 0
    v_mov_b32 v229, 0
    v_mov_b32 v230, 0
    v_mov_b32 v231, 0
    v_mov_b32 v232, 0
    v_mov_b32 v233, 0
    v_mov_b32 v234, 0
    v_mov_b32 v235, 0
    v_mov_b32 v236, 0
    v_mov_b32 v237, 0
    v_mov_b32 v238, 0
    v_mov_b32 v239, 0
    v_mov_b32 v240, 0
    v_mov_b32 v241, 0
    v_mov_b32 v242, 0
    v_mov_b32 v243, 0
    v_mov_b32 v244, 0
    v_mov_b32 v245, 0
    v_mov_b32 v246, 0
    v_mov_b32 v247, 0
    v_mov_b32 v248, 0
    v_mov_b32 v249, 0
    v_mov_b32 v250, 0
    v_mov_b32 v251, 0
    v_mov_b32 v252, 0
    v_mov_b32 v253, 0
    v_mov_b32 v254, 0
    v_mov_b32 v255, 0
    s_mov_b32 s40, 0
    s_mov_b32 s43, 0
    s_mov_b32 s41, 9
    s_barrier
    ds_read_b128 v[24:27], v52 offset:0
    ds_read_b128 v[8:11], v48 offset:0
    ds_read_b128 v[28:31], v52 offset:2048
    ds_read_b128 v[12:15], v48 offset:4096
    ds_read_b128 v[32:35], v52 offset:4096
    ds_read_b128 v[16:19], v48 offset:8192
L_k1_nt_cloop:
    s_waitcnt lgkmcnt(1)
    v_mfma_f32_32x32x16_bf16 v[64:79], v[24:27], v[8:11], v[64:79]
    ds_read_b128 v[20:23], v48 offset:12288
    v_mfma_f32_32x32x16_bf16 v[80:95], v[28:31], v[8:11], v[80:95]
    ds_read_b128 v[36:39], v53 offset:0
    v_mfma_f32_32x32x16_bf16 v[96:111], v[32:35], v[8:11], v[96:111]
    v_mfma_f32_32x32x16_bf16 v[112:127], v[24:27], v[12:15], v[112:127]
    ds_read_b128 v[8:11], v49 offset:0
    v_mfma_f32_32x32x16_bf16 v[128:143], v[28:31], v[12:15], v[128:143]
    ds_read_b128 v[40:43], v53 offset:2048
    v_mfma_f32_32x32x16_bf16 v[144:159], v[32:35], v[12:15], v[144:159]
    s_waitcnt lgkmcnt(4)
    v_mfma_f32_32x32x16_bf16 v[160:175], v[24:27], v[16:19], v[160:175]
    ds_read_b128 v[12:15], v49 offset:4096
    v_mfma_f32_32x32x16_bf16 v[176:191], v[28:31], v[16:19], v[176:191]
    ds_read_b128 v[44:47], v53 offset:4096
    v_mfma_f32_32x32x16_bf16 v[192:207], v[32:35], v[16:19], v[192:207]
    s_waitcnt lgkmcnt(5)
    v_mfma_f32_32x32x16_bf16 v[208:223], v[24:27], v[20:23], v[208:223]
    ds_read_b128 v[16:19], v49 offset:8192
    v_mfma_f32_32x32x16_bf16 v[224:239], v[28:31], v[20:23], v[224:239]
    v_mfma_f32_32x32x16_bf16 v[240:255], v[32:35], v[20:23], v[240:255]
    s_add_u32 s40, s40, 1
    s_cmp_eq_u32 s40, 5
    s_mov_b32 s42, 12288
    s_cselect_b32 s42, -49152, s42
    s_cselect_b32 s40, 0, s40
    v_add_u32 v52, s42, v52
    v_add_u32 v53, s42, v53
    s_waitcnt lgkmcnt(1)
    v_mfma_f32_32x32x16_bf16 v[64:79], v[36:39], v[8:11], v[64:79]
    ds_read_b128 v[20:23], v49 offset:12288
    v_mfma_f32_32x32x16_bf16 v[80:95], v[40:43], v[8:11], v[80:95]
    ds_read_b128 v[24:27], v52 offset:0
    v_mfma_f32_32x32x16_bf16 v[96:111], v[44:47], v[8:11], v[96:111]
    v_mfma_f32_32x32x16_bf16 v[112:127], v[36:39], v[12:15], v[112:127]
    ds_read_b128 v[8:11], v50 offset:0
    v_mfma_f32_32x32x16_bf16 v[128:143], v[40:43], v[12:15], v[128:143]
    ds_read_b128 v[28:31], v52 offset:2048
    v_mfma_f32_32x32x16_bf16 v[144:159], v[44:47], v[12:15], v[144:159]
    s_waitcnt lgkmcnt(4)
    v_mfma_f32_32x32x16_bf16 v[160:175], v[36:39], v[16:19], v[160:175]
    ds_read_b128 v[12:15], v50 offset:4096
    v_mfma_f32_32x32x16_bf16 v[176:191], v[40:43], v[16:19], v[176:191]
    ds_read_b128 v[32:35], v52 offset:4096
    v_mfma_f32_32x32x16_bf16 v[192:207], v[44:47], v[16:19], v[192:207]
    s_waitcnt lgkmcnt(5)
    v_mfma_f32_32x32x16_bf16 v[208:223], v[36:39], v[20:23], v[208:223]
    ds_read_b128 v[16:19], v50 offset:8192
    v_mfma_f32_32x32x16_bf16 v[224:239], v[40:43], v[20:23], v[224:239]
    v_mfma_f32_32x32x16_bf16 v[240:255], v[44:47], v[20:23], v[240:255]
    s_barrier
    s_waitcnt lgkmcnt(1)
    v_mfma_f32_32x32x16_bf16 v[64:79], v[24:27], v[8:11], v[64:79]
    ds_read_b128 v[20:23], v50 offset:12288
    v_mfma_f32_32x32x16_bf16 v[80:95], v[28:31], v[8:11], v[80:95]
    ds_read_b128 v[36:39], v53 offset:0
    v_mfma_f32_32x32x16_bf16 v[96:111], v[32:35], v[8:11], v[96:111]
    v_mfma_f32_32x32x16_bf16 v[112:127], v[24:27], v[12:15], v[112:127]
    ds_read_b128 v[8:11], v51 offset:0
    v_mfma_f32_32x32x16_bf16 v[128:143], v[28:31], v[12:15], v[128:143]
    ds_read_b128 v[40:43], v53 offset:2048
    v_mfma_f32_32x32x16_bf16 v[144:159], v[32:35], v[12:15], v[144:159]
    s_waitcnt lgkmcnt(4)
    v_mfma_f32_32x32x16_bf16 v[160:175], v[24:27], v[16:19], v[160:175]
    ds_read_b128 v[12:15], v51 offset:4096
    v_mfma_f32_32x32x16_bf16 v[176:191], v[28:31], v[16:19], v[176:191]
    ds_read_b128 v[44:47], v53 offset:4096
    v_mfma_f32_32x32x16_bf16 v[192:207], v[32:35], v[16:19], v[192:207]
    s_waitcnt lgkmcnt(5)
    v_mfma_f32_32x32x16_bf16 v[208:223], v[24:27], v[20:23], v[208:223]
    ds_read_b128 v[16:19], v51 offset:8192
    v_mfma_f32_32x32x16_bf16 v[224:239], v[28:31], v[20:23], v[224:239]
    v_mfma_f32_32x32x16_bf16 v[240:255], v[32:35], v[20:23], v[240:255]
    s_add_u32 s40, s40, 1
    s_cmp_eq_u32 s40, 5
    s_mov_b32 s42, 12288
    s_cselect_b32 s42, -49152, s42
    s_cselect_b32 s40, 0, s40
    v_add_u32 v52, s42, v52
    v_add_u32 v53, s42, v53
    s_add_u32 s43, s43, 1
    s_cmp_eq_u32 s43, 3
    s_mov_b32 s45, 32768
    s_cselect_b32 s45, -65536, s45
    s_cselect_b32 s43, 0, s43
    v_add_u32 v48, s45, v48
    v_add_u32 v49, s45, v49
    v_add_u32 v50, s45, v50
    s_waitcnt lgkmcnt(1)
    v_mfma_f32_32x32x16_bf16 v[64:79], v[36:39], v[8:11], v[64:79]
    ds_read_b128 v[20:23], v51 offset:12288
    v_add_u32 v51, s45, v51
    v_mfma_f32_32x32x16_bf16 v[80:95], v[40:43], v[8:11], v[80:95]
    ds_read_b128 v[24:27], v52 offset:0
    v_mfma_f32_32x32x16_bf16 v[96:111], v[44:47], v[8:11], v[96:111]
    v_mfma_f32_32x32x16_bf16 v[112:127], v[36:39], v[12:15], v[112:127]
    ds_read_b128 v[8:11], v48 offset:0
    v_mfma_f32_32x32x16_bf16 v[128:143], v[40:43], v[12:15], v[128:143]
    ds_read_b128 v[28:31], v52 offset:2048
    v_mfma_f32_32x32x16_bf16 v[144:159], v[44:47], v[12:15], v[144:159]
    s_waitcnt lgkmcnt(4)
    v_mfma_f32_32x32x16_bf16 v[160:175], v[36:39], v[16:19], v[160:175]
    ds_read_b128 v[12:15], v48 offset:4096
    v_mfma_f32_32x32x16_bf16 v[176:191], v[40:43], v[16:19], v[176:191]
    ds_read_b128 v[32:35], v52 offset:4096
    v_mfma_f32_32x32x16_bf16 v[192:207], v[44:47], v[16:19], v[192:207]
    s_waitcnt lgkmcnt(5)
    v_mfma_f32_32x32x16_bf16 v[208:223], v[36:39], v[20:23], v[208:223]
    ds_read_b128 v[16:19], v48 offset:8192
    v_mfma_f32_32x32x16_bf16 v[224:239], v[40:43], v[20:23], v[224:239]
    v_mfma_f32_32x32x16_bf16 v[240:255], v[44:47], v[20:23], v[240:255]
    s_sub_u32 s41, s41, 1
    s_cmp_lg_u32 s41, 0
    s_barrier
    s_cbranch_scc1 L_k1_nt_cloop
    s_waitcnt lgkmcnt(0)
    s_nop 15
    v_and_b32 v3, 31, v2
    v_lshrrev_b32 v4, 5, v2
    s_lshl_b32 s38, s36, 7
    v_add_u32 v3, s38, v3
    v_mul_u32_u24 v3, 400, v3
    v_lshl_add_u32 v3, v4, 3, v3
    s_mul_i32 s38, s37, 192
    v_add_u32 v3, s38, v3
    v_cvt_pk_bf16_f32 v8, v64, v65
    v_cvt_pk_bf16_f32 v9, v66, v67
    ds_write_b64 v3, v[8:9] offset:0
    v_cvt_pk_bf16_f32 v10, v68, v69
    v_cvt_pk_bf16_f32 v11, v70, v71
    ds_write_b64 v3, v[10:11] offset:16
    v_cvt_pk_bf16_f32 v12, v72, v73
    v_cvt_pk_bf16_f32 v13, v74, v75
    ds_write_b64 v3, v[12:13] offset:32
    v_cvt_pk_bf16_f32 v14, v76, v77
    v_cvt_pk_bf16_f32 v15, v78, v79
    ds_write_b64 v3, v[14:15] offset:48
    v_cvt_pk_bf16_f32 v16, v80, v81
    v_cvt_pk_bf16_f32 v17, v82, v83
    ds_write_b64 v3, v[16:17] offset:64
    v_cvt_pk_bf16_f32 v18, v84, v85
    v_cvt_pk_bf16_f32 v19, v86, v87
    ds_write_b64 v3, v[18:19] offset:80
    v_cvt_pk_bf16_f32 v20, v88, v89
    v_cvt_pk_bf16_f32 v21, v90, v91
    ds_write_b64 v3, v[20:21] offset:96
    v_cvt_pk_bf16_f32 v22, v92, v93
    v_cvt_pk_bf16_f32 v23, v94, v95
    ds_write_b64 v3, v[22:23] offset:112
    v_cvt_pk_bf16_f32 v24, v96, v97
    v_cvt_pk_bf16_f32 v25, v98, v99
    ds_write_b64 v3, v[24:25] offset:128
    v_cvt_pk_bf16_f32 v26, v100, v101
    v_cvt_pk_bf16_f32 v27, v102, v103
    ds_write_b64 v3, v[26:27] offset:144
    v_cvt_pk_bf16_f32 v28, v104, v105
    v_cvt_pk_bf16_f32 v29, v106, v107
    ds_write_b64 v3, v[28:29] offset:160
    v_cvt_pk_bf16_f32 v30, v108, v109
    v_cvt_pk_bf16_f32 v31, v110, v111
    ds_write_b64 v3, v[30:31] offset:176
    v_cvt_pk_bf16_f32 v32, v112, v113
    v_cvt_pk_bf16_f32 v33, v114, v115
    ds_write_b64 v3, v[32:33] offset:12800
    v_cvt_pk_bf16_f32 v34, v116, v117
    v_cvt_pk_bf16_f32 v35, v118, v119
    ds_write_b64 v3, v[34:35] offset:12816
    v_cvt_pk_bf16_f32 v36, v120, v121
    v_cvt_pk_bf16_f32 v37, v122, v123
    ds_write_b64 v3, v[36:37] offset:12832
    v_cvt_pk_bf16_f32 v38, v124, v125
    v_cvt_pk_bf16_f32 v39, v126, v127
    ds_write_b64 v3, v[38:39] offset:12848
    v_cvt_pk_bf16_f32 v8, v128, v129
    v_cvt_pk_bf16_f32 v9, v130, v131
    ds_write_b64 v3, v[8:9] offset:12864
    v_cvt_pk_bf16_f32 v10, v132, v133
    v_cvt_pk_bf16_f32 v11, v134, v135
    ds_write_b64 v3, v[10:11] offset:12880
    v_cvt_pk_bf16_f32 v12, v136, v137
    v_cvt_pk_bf16_f32 v13, v138, v139
    ds_write_b64 v3, v[12:13] offset:12896
    v_cvt_pk_bf16_f32 v14, v140, v141
    v_cvt_pk_bf16_f32 v15, v142, v143
    ds_write_b64 v3, v[14:15] offset:12912
    v_cvt_pk_bf16_f32 v16, v144, v145
    v_cvt_pk_bf16_f32 v17, v146, v147
    ds_write_b64 v3, v[16:17] offset:12928
    v_cvt_pk_bf16_f32 v18, v148, v149
    v_cvt_pk_bf16_f32 v19, v150, v151
    ds_write_b64 v3, v[18:19] offset:12944
    v_cvt_pk_bf16_f32 v20, v152, v153
    v_cvt_pk_bf16_f32 v21, v154, v155
    ds_write_b64 v3, v[20:21] offset:12960
    v_cvt_pk_bf16_f32 v22, v156, v157
    v_cvt_pk_bf16_f32 v23, v158, v159
    ds_write_b64 v3, v[22:23] offset:12976
    v_cvt_pk_bf16_f32 v24, v160, v161
    v_cvt_pk_bf16_f32 v25, v162, v163
    ds_write_b64 v3, v[24:25] offset:25600
    v_cvt_pk_bf16_f32 v26, v164, v165
    v_cvt_pk_bf16_f32 v27, v166, v167
    ds_write_b64 v3, v[26:27] offset:25616
    v_cvt_pk_bf16_f32 v28, v168, v169
    v_cvt_pk_bf16_f32 v29, v170, v171
    ds_write_b64 v3, v[28:29] offset:25632
    v_cvt_pk_bf16_f32 v30, v172, v173
    v_cvt_pk_bf16_f32 v31, v174, v175
    ds_write_b64 v3, v[30:31] offset:25648
    v_cvt_pk_bf16_f32 v32, v176, v177
    v_cvt_pk_bf16_f32 v33, v178, v179
    ds_write_b64 v3, v[32:33] offset:25664
    v_cvt_pk_bf16_f32 v34, v180, v181
    v_cvt_pk_bf16_f32 v35, v182, v183
    ds_write_b64 v3, v[34:35] offset:25680
    v_cvt_pk_bf16_f32 v36, v184, v185
    v_cvt_pk_bf16_f32 v37, v186, v187
    ds_write_b64 v3, v[36:37] offset:25696
    v_cvt_pk_bf16_f32 v38, v188, v189
    v_cvt_pk_bf16_f32 v39, v190, v191
    ds_write_b64 v3, v[38:39] offset:25712
    v_cvt_pk_bf16_f32 v8, v192, v193
    v_cvt_pk_bf16_f32 v9, v194, v195
    ds_write_b64 v3, v[8:9] offset:25728
    v_cvt_pk_bf16_f32 v10, v196, v197
    v_cvt_pk_bf16_f32 v11, v198, v199
    ds_write_b64 v3, v[10:11] offset:25744
    v_cvt_pk_bf16_f32 v12, v200, v201
    v_cvt_pk_bf16_f32 v13, v202, v203
    ds_write_b64 v3, v[12:13] offset:25760
    v_cvt_pk_bf16_f32 v14, v204, v205
    v_cvt_pk_bf16_f32 v15, v206, v207
    ds_write_b64 v3, v[14:15] offset:25776
    v_cvt_pk_bf16_f32 v16, v208, v209
    v_cvt_pk_bf16_f32 v17, v210, v211
    ds_write_b64 v3, v[16:17] offset:38400
    v_cvt_pk_bf16_f32 v18, v212, v213
    v_cvt_pk_bf16_f32 v19, v214, v215
    ds_write_b64 v3, v[18:19] offset:38416
    v_cvt_pk_bf16_f32 v20, v216, v217
    v_cvt_pk_bf16_f32 v21, v218, v219
    ds_write_b64 v3, v[20:21] offset:38432
    v_cvt_pk_bf16_f32 v22, v220, v221
    v_cvt_pk_bf16_f32 v23, v222, v223
    ds_write_b64 v3, v[22:23] offset:38448
    v_cvt_pk_bf16_f32 v24, v224, v225
    v_cvt_pk_bf16_f32 v25, v226, v227
    ds_write_b64 v3, v[24:25] offset:38464
    v_cvt_pk_bf16_f32 v26, v228, v229
    v_cvt_pk_bf16_f32 v27, v230, v231
    ds_write_b64 v3, v[26:27] offset:38480
    v_cvt_pk_bf16_f32 v28, v232, v233
    v_cvt_pk_bf16_f32 v29, v234, v235
    ds_write_b64 v3, v[28:29] offset:38496
    v_cvt_pk_bf16_f32 v30, v236, v237
    v_cvt_pk_bf16_f32 v31, v238, v239
    ds_write_b64 v3, v[30:31] offset:38512
    v_cvt_pk_bf16_f32 v32, v240, v241
    v_cvt_pk_bf16_f32 v33, v242, v243
    ds_write_b64 v3, v[32:33] offset:38528
    v_cvt_pk_bf16_f32 v34, v244, v245
    v_cvt_pk_bf16_f32 v35, v246, v247
    ds_write_b64 v3, v[34:35] offset:38544
    v_cvt_pk_bf16_f32 v36, v248, v249
    v_cvt_pk_bf16_f32 v37, v250, v251
    ds_write_b64 v3, v[36:37] offset:38560
    v_cvt_pk_bf16_f32 v38, v252, v253
    v_cvt_pk_bf16_f32 v39, v254, v255
    ds_write_b64 v3, v[38:39] offset:38576
    s_waitcnt lgkmcnt(0)
    s_branch L_k1_nt_epi
L_k1_nt_loader:
    s_sub_u32 s36, s32, 4
    v_lshrrev_b32 v3, 3, v2
    v_and_b32 v4, 7, v2
    v_lshrrev_b32 v5, 4, v2
    v_xor_b32 v4, v4, v5
    s_lshl_b32 s37, s36, 6
    s_add_u32 s37, s37, s33
    v_add_u32 v5, s37, v3
    v_mul_u32_u24 v5, 1152, v5
    v_lshl_add_u32 v8, v4, 4, v5
    v_xor_b32 v4, 4, v4
    v_lshl_add_u32 v9, v4, 4, v5
    v_lshrrev_b32 v3, 2, v2
    v_and_b32 v4, 3, v2
    v_bfe_u32 v5, v2, 4, 2
    v_xor_b32 v4, v4, v5
    s_mul_i32 s37, s36, 48
    s_add_u32 s37, s37, s34
    v_add_u32 v5, s37, v3
    v_mul_u32_u24 v5, 1152, v5
    v_lshl_add_u32 v10, v4, 4, v5
    s_lshl_b32 s38, s36, 13
    s_mul_i32 s39, s36, 3072
    s_add_u32 s39, s39, 98304
    s_mov_b32 s40, 0
    s_mov_b32 s46, 0
    s_mov_b32 s43, 0
    s_mov_b32 s44, 0
    s_add_u32 m0, s38, 0
    s_add_u32 s45, s43, 0
    buffer_load_dwordx4 v8, s[16:19], s45 offen lds
    s_add_u32 m0, s38, 1024
    s_add_u32 s45, s43, 9216
    buffer_load_dwordx4 v9, s[16:19], s45 offen lds
    s_add_u32 m0, s38, 2048
    s_add_u32 s45, s43, 18432
    buffer_load_dwordx4 v8, s[16:19], s45 offen lds
    s_add_u32 m0, s38, 3072
    s_add_u32 s45, s43, 27648
    buffer_load_dwordx4 v9, s[16:19], s45 offen lds
    s_add_u32 m0, s38, 4096
    s_add_u32 s45, s43, 36864
    buffer_load_dwordx4 v8, s[16:19], s45 offen lds
    s_add_u32 m0, s38, 5120
    s_add_u32 s45, s43, 46080
    buffer_load_dwordx4 v9, s[16:19], s45 offen lds
    s_add_u32 m0, s38, 6144
    s_add_u32 s45, s43, 55296
    buffer_load_dwordx4 v8, s[16:19], s45 offen lds
    s_add_u32 m0, s38, 7168
    s_add_u32 s45, s43, 64512
    buffer_load_dwordx4 v9, s[16:19], s45 offen lds
    s_add_u32 s43, s43, 128
    s_add_u32 s46, s46, 1
    s_cmp_eq_u32 s46, 3
    s_mov_b32 s42, 32768
    s_cselect_b32 s42, -65536, s42
    s_cselect_b32 s46, 0, s46
    s_add_u32 s38, s38, s42
    s_add_u32 m0, s39, 0
    s_add_u32 s45, s44, 0
    buffer_load_dwordx4 v10, s[20:23], s45 offen lds
    s_add_u32 m0, s39, 1024
    s_add_u32 s45, s44, 18432
    buffer_load_dwordx4 v10, s[20:23], s45 offen lds
    s_add_u32 m0, s39, 2048
    s_add_u32 s45, s44, 36864
    buffer_load_dwordx4 v10, s[20:23], s45 offen lds
    s_add_u32 s44, s44, 64
    s_add_u32 s40, s40, 1
    s_cmp_eq_u32 s40, 5
    s_mov_b32 s42, 12288
    s_cselect_b32 s42, -49152, s42
    s_cselect_b32 s40, 0, s40
    s_add_u32 s39, s39, s42
    s_add_u32 m0, s39, 0
    s_add_u32 s45, s44, 0
    buffer_load_dwordx4 v10, s[20:23], s45 offen lds
    s_add_u32 m0, s39, 1024
    s_add_u32 s45, s44, 18432
    buffer_load_dwordx4 v10, s[20:23], s45 offen lds
    s_add_u32 m0, s39, 2048
    s_add_u32 s45, s44, 36864
    buffer_load_dwordx4 v10, s[20:23], s45 offen lds
    s_add_u32 s44, s44, 64
    s_add_u32 s40, s40, 1
    s_cmp_eq_u32 s40, 5
    s_mov_b32 s42, 12288
    s_cselect_b32 s42, -49152, s42
    s_cselect_b32 s40, 0, s40
    s_add_u32 s39, s39, s42
    s_add_u32 m0, s38, 0
    s_add_u32 s45, s43, 0
    buffer_load_dwordx4 v8, s[16:19], s45 offen lds
    s_add_u32 m0, s38, 1024
    s_add_u32 s45, s43, 9216
    buffer_load_dwordx4 v9, s[16:19], s45 offen lds
    s_add_u32 m0, s38, 2048
    s_add_u32 s45, s43, 18432
    buffer_load_dwordx4 v8, s[16:19], s45 offen lds
    s_add_u32 m0, s38, 3072
    s_add_u32 s45, s43, 27648
    buffer_load_dwordx4 v9, s[16:19], s45 offen lds
    s_add_u32 m0, s38, 4096
    s_add_u32 s45, s43, 36864
    buffer_load_dwordx4 v8, s[16:19], s45 offen lds
    s_add_u32 m0, s38, 5120
    s_add_u32 s45, s43, 46080
    buffer_load_dwordx4 v9, s[16:19], s45 offen lds
    s_add_u32 m0, s38, 6144
    s_add_u32 s45, s43, 55296
    buffer_load_dwordx4 v8, s[16:19], s45 offen lds
    s_add_u32 m0, s38, 7168
    s_add_u32 s45, s43, 64512
    buffer_load_dwordx4 v9, s[16:19], s45 offen lds
    s_add_u32 s43, s43, 128
    s_add_u32 s46, s46, 1
    s_cmp_eq_u32 s46, 3
    s_mov_b32 s42, 32768
    s_cselect_b32 s42, -65536, s42
    s_cselect_b32 s46, 0, s46
    s_add_u32 s38, s38, s42
    s_add_u32 m0, s39, 0
    s_add_u32 s45, s44, 0
    buffer_load_dwordx4 v10, s[20:23], s45 offen lds
    s_add_u32 m0, s39, 1024
    s_add_u32 s45, s44, 18432
    buffer_load_dwordx4 v10, s[20:23], s45 offen lds
    s_add_u32 m0, s39, 2048
    s_add_u32 s45, s44, 36864
    buffer_load_dwordx4 v10, s[20:23], s45 offen lds
    s_add_u32 s44, s44, 64
    s_add_u32 s40, s40, 1
    s_cmp_eq_u32 s40, 5
    s_mov_b32 s42, 12288
    s_cselect_b32 s42, -49152, s42
    s_cselect_b32 s40, 0, s40
    s_add_u32 s39, s39, s42
    s_add_u32 m0, s39, 0
    s_add_u32 s45, s44, 0
    buffer_load_dwordx4 v10, s[20:23], s45 offen lds
    s_add_u32 m0, s39, 1024
    s_add_u32 s45, s44, 18432
    buffer_load_dwordx4 v10, s[20:23], s45 offen lds
    s_add_u32 m0, s39, 2048
    s_add_u32 s45, s44, 36864
    buffer_load_dwordx4 v10, s[20:23], s45 offen lds
    s_add_u32 s44, s44, 64
    s_add_u32 s40, s40, 1
    s_cmp_eq_u32 s40, 5
    s_mov_b32 s42, 12288
    s_cselect_b32 s42, -49152, s42
    s_cselect_b32 s40, 0, s40
    s_add_u32 s39, s39, s42
    s_waitcnt vmcnt(14)
    s_barrier
    s_mov_b32 s41, 7
L_k1_nt_lloop:
    s_add_u32 m0, s39, 0
    s_add_u32 s45, s44, 0
    buffer_load_dwordx4 v10, s[20:23], s45 offen lds
    s_add_u32 m0, s39, 1024
    s_add_u32 s45, s44, 18432
    buffer_load_dwordx4 v10, s[20:23], s45 offen lds
    s_add_u32 m0, s39, 2048
    s_add_u32 s45, s44, 36864
    buffer_load_dwordx4 v10, s[20:23], s45 offen lds
    s_add_u32 s44, s44, 64
    s_add_u32 s40, s40, 1
    s_cmp_eq_u32 s40, 5
    s_mov_b32 s42, 12288
    s_cselect_b32 s42, -49152, s42
    s_cselect_b32 s40, 0, s40
    s_add_u32 s39, s39, s42
    s_add_u32 m0, s38, 0
    s_add_u32 s45, s43, 0
    buffer_load_dwordx4 v8, s[16:19], s45 offen lds
    s_add_u32 m0, s38, 1024
    s_add_u32 s45, s43, 9216
    buffer_load_dwordx4 v9, s[16:19], s45 offen lds
    s_add_u32 m0, s38, 2048
    s_add_u32 s45, s43, 18432
    buffer_load_dwordx4 v8, s[16:19], s45 offen lds
    s_add_u32 m0, s38, 3072
    s_add_u32 s45, s43, 27648
    buffer_load_dwordx4 v9, s[16:19], s45 offen lds
    s_add_u32 m0, s38, 4096
    s_add_u32 s45, s43, 36864
    buffer_load_dwordx4 v8, s[16:19], s45 offen lds
    s_add_u32 m0, s38, 5120
    s_add_u32 s45, s43, 46080
    buffer_load_dwordx4 v9, s[16:19], s45 offen lds
    s_add_u32 m0, s38, 6144
    s_add_u32 s45, s43, 55296
    buffer_load_dwordx4 v8, s[16:19], s45 offen lds
    s_add_u32 m0, s38, 7168
    s_add_u32 s45, s43, 64512
    buffer_load_dwordx4 v9, s[16:19], s45 offen lds
    s_add_u32 s43, s43, 128
    s_add_u32 s46, s46, 1
    s_cmp_eq_u32 s46, 3
    s_mov_b32 s42, 32768
    s_cselect_b32 s42, -65536, s42
    s_cselect_b32 s46, 0, s46
    s_add_u32 s38, s38, s42
    s_waitcnt vmcnt(14)
    s_barrier
    s_add_u32 m0, s39, 0
    s_add_u32 s45, s44, 0
    buffer_load_dwordx4 v10, s[20:23], s45 offen lds
    s_add_u32 m0, s39, 1024
    s_add_u32 s45, s44, 18432
    buffer_load_dwordx4 v10, s[20:23], s45 offen lds
    s_add_u32 m0, s39, 2048
    s_add_u32 s45, s44, 36864
    buffer_load_dwordx4 v10, s[20:23], s45 offen lds
    s_add_u32 s44, s44, 64
    s_add_u32 s40, s40, 1
    s_cmp_eq_u32 s40, 5
    s_mov_b32 s42, 12288
    s_cselect_b32 s42, -49152, s42
    s_cselect_b32 s40, 0, s40
    s_add_u32 s39, s39, s42
    s_sub_u32 s41, s41, 1
    s_cmp_lg_u32 s41, 0
    s_waitcnt vmcnt(14)
    s_barrier
    s_cbranch_scc1 L_k1_nt_lloop
    s_waitcnt vmcnt(3)
    s_barrier
    s_waitcnt vmcnt(0)
    s_barrier
    s_barrier
    s_barrier
L_k1_nt_epi:
    v_add_u32 v3, 0, v0
    v_mul_u32_u24 v4, 2731, v3
    v_lshrrev_b32 v4, 16, v4
    v_mul_u32_u24 v5, 24, v4
    v_sub_u32 v5, v3, v5
    v_mul_u32_u24 v6, 400, v4
    v_lshl_add_u32 v8, v5, 4, v6
    v_add_u32 v4, s33, v4
    v_lshl_add_u32 v5, v5, 3, s34
    v_mul_u32_u24 v6, 7282, v5
    v_lshrrev_b32 v6, 20, v6
    v_mul_u32_u24 v7, 144, v6
    v_sub_u32 v5, v5, v7
    v_mul_u32_u24 v4, 288, v4
    v_lshl_add_u32 v4, v5, 1, v4
    s_mov_b32 s37, 589824
    v_mul_lo_u32 v6, v6, s37
    v_add_u32 v11, v4, v6
    v_add_u32 v3, 512, v0
    v_mul_u32_u24 v4, 2731, v3
    v_lshrrev_b32 v4, 16, v4
    v_mul_u32_u24 v5, 24, v4
    v_sub_u32 v5, v3, v5
    v_mul_u32_u24 v6, 400, v4
    v_lshl_add_u32 v9, v5, 4, v6
    v_add_u32 v4, s33, v4
    v_lshl_add_u32 v5, v5, 3, s34
    v_mul_u32_u24 v6, 7282, v5
    v_lshrrev_b32 v6, 20, v6
    v_mul_u32_u24 v7, 144, v6
    v_sub_u32 v5, v5, v7
    v_mul_u32_u24 v4, 288, v4
    v_lshl_add_u32 v4, v5, 1, v4
    s_mov_b32 s37, 589824
    v_mul_lo_u32 v6, v6, s37
    v_add_u32 v12, v4, v6
    v_add_u32 v3, 1024, v0
    v_mul_u32_u24 v4, 2731, v3
    v_lshrrev_b32 v4, 16, v4
    v_mul_u32_u24 v5, 24, v4
    v_sub_u32 v5, v3, v5
    v_mul_u32_u24 v6, 400, v4
    v_lshl_add_u32 v10, v5, 4, v6
    v_add_u32 v4, s33, v4
    v_lshl_add_u32 v5, v5, 3, s34
    v_mul_u32_u24 v6, 7282, v5
    v_lshrrev_b32 v6, 20, v6
    v_mul_u32_u24 v7, 144, v6
    v_sub_u32 v5, v5, v7
    v_mul_u32_u24 v4, 288, v4
    v_lshl_add_u32 v4, v5, 1, v4
    s_mov_b32 s37, 589824
    v_mul_lo_u32 v6, v6, s37
    v_add_u32 v13, v4, v6
    s_mov_b32 s46, 0xffff0000
    s_barrier
    s_mov_b32 s37, 0
    s_mov_b32 s41, 4
L_k1_nt_eloop:
    ds_read_b128 v[40:43], v8
    v_add_u32 v8, 25600, v8
    ds_read_b128 v[64:67], v9
    v_add_u32 v9, 25600, v9
    ds_read_b128 v[88:91], v10
    v_add_u32 v10, 25600, v10
    s_waitcnt lgkmcnt(2)
    buffer_store_dwordx4 v[40:43], v11, s[24:27], s37 offen
    s_waitcnt lgkmcnt(1)
    buffer_store_dwordx4 v[64:67], v12, s[24:27], s37 offen
    s_waitcnt lgkmcnt(0)
    buffer_store_dwordx4 v[88:91], v13, s[24:27], s37 offen
    s_add_u32 s37, s37, 18432
    s_sub_u32 s41, s41, 1
    s_cmp_lg_u32 s41, 0
    s_cbranch_scc1 L_k1_nt_eloop
    s_endpgm
L_k1_copy:
    s_load_dwordx2 s[8:9], s[0:1], 64
    s_load_dwordx2 s[12:13], s[0:1], 96
    s_sub_u32 s33, s2, 240
    s_mul_i32 s33, s33, 20736
    v_add_u32 v1, s33, v0
    s_waitcnt lgkmcnt(0)
    s_mov_b32 s16, s8
    s_mov_b32 s17, s9
    s_mov_b32 s18, 5308416
    s_mov_b32 s19, 0x00020000
    s_add_u32 s20, s12, 47251456
    s_addc_u32 s21, s13, 0
    s_mov_b32 s22, 5308416
    s_mov_b32 s23, 0x00020000
    s_mov_b32 s34, 59652324
    s_mov_b32 s41, 5
L_k1_copy_loop:
    v_add_u32 v8, 0, v1
    v_lshlrev_b32 v9, 4, v8
    buffer_load_dwordx4 v[12:15], v9, s[16:19], 0 offen
    v_mul_hi_u32 v9, v8, s34
    v_mul_u32_u24 v10, 72, v9
    v_sub_u32 v10, v8, v10
    v_mul_u32_u24 v11, 3641, v10
    v_lshrrev_b32 v11, 16, v11
    v_mul_u32_u24 v8, 18, v11
    v_sub_u32 v10, v10, v8
    v_mul_u32_u24 v9, 288, v9
    v_lshl_add_u32 v9, v10, 4, v9
    s_mov_b32 s35, 1327104
    v_mul_lo_u32 v11, v11, s35
    v_add_u32 v9, v9, v11
    v_add_u32 v16, 512, v1
    v_lshlrev_b32 v17, 4, v16
    buffer_load_dwordx4 v[20:23], v17, s[16:19], 0 offen
    v_mul_hi_u32 v17, v16, s34
    v_mul_u32_u24 v18, 72, v17
    v_sub_u32 v18, v16, v18
    v_mul_u32_u24 v19, 3641, v18
    v_lshrrev_b32 v19, 16, v19
    v_mul_u32_u24 v16, 18, v19
    v_sub_u32 v18, v18, v16
    v_mul_u32_u24 v17, 288, v17
    v_lshl_add_u32 v17, v18, 4, v17
    s_mov_b32 s35, 1327104
    v_mul_lo_u32 v19, v19, s35
    v_add_u32 v17, v17, v19
    v_add_u32 v24, 1024, v1
    v_lshlrev_b32 v25, 4, v24
    buffer_load_dwordx4 v[28:31], v25, s[16:19], 0 offen
    v_mul_hi_u32 v25, v24, s34
    v_mul_u32_u24 v26, 72, v25
    v_sub_u32 v26, v24, v26
    v_mul_u32_u24 v27, 3641, v26
    v_lshrrev_b32 v27, 16, v27
    v_mul_u32_u24 v24, 18, v27
    v_sub_u32 v26, v26, v24
    v_mul_u32_u24 v25, 288, v25
    v_lshl_add_u32 v25, v26, 4, v25
    s_mov_b32 s35, 1327104
    v_mul_lo_u32 v27, v27, s35
    v_add_u32 v25, v25, v27
    v_add_u32 v32, 1536, v1
    v_lshlrev_b32 v33, 4, v32
    buffer_load_dwordx4 v[36:39], v33, s[16:19], 0 offen
    v_mul_hi_u32 v33, v32, s34
    v_mul_u32_u24 v34, 72, v33
    v_sub_u32 v34, v32, v34
    v_mul_u32_u24 v35, 3641, v34
    v_lshrrev_b32 v35, 16, v35
    v_mul_u32_u24 v32, 18, v35
    v_sub_u32 v34, v34, v32
    v_mul_u32_u24 v33, 288, v33
    v_lshl_add_u32 v33, v34, 4, v33
    s_mov_b32 s35, 1327104
    v_mul_lo_u32 v35, v35, s35
    v_add_u32 v33, v33, v35
    v_add_u32 v40, 2048, v1
    v_lshlrev_b32 v41, 4, v40
    buffer_load_dwordx4 v[44:47], v41, s[16:19], 0 offen
    v_mul_hi_u32 v41, v40, s34
    v_mul_u32_u24 v42, 72, v41
    v_sub_u32 v42, v40, v42
    v_mul_u32_u24 v43, 3641, v42
    v_lshrrev_b32 v43, 16, v43
    v_mul_u32_u24 v40, 18, v43
    v_sub_u32 v42, v42, v40
    v_mul_u32_u24 v41, 288, v41
    v_lshl_add_u32 v41, v42, 4, v41
    s_mov_b32 s35, 1327104
    v_mul_lo_u32 v43, v43, s35
    v_add_u32 v41, v41, v43
    v_add_u32 v48, 2560, v1
    v_lshlrev_b32 v49, 4, v48
    buffer_load_dwordx4 v[52:55], v49, s[16:19], 0 offen
    v_mul_hi_u32 v49, v48, s34
    v_mul_u32_u24 v50, 72, v49
    v_sub_u32 v50, v48, v50
    v_mul_u32_u24 v51, 3641, v50
    v_lshrrev_b32 v51, 16, v51
    v_mul_u32_u24 v48, 18, v51
    v_sub_u32 v50, v50, v48
    v_mul_u32_u24 v49, 288, v49
    v_lshl_add_u32 v49, v50, 4, v49
    s_mov_b32 s35, 1327104
    v_mul_lo_u32 v51, v51, s35
    v_add_u32 v49, v49, v51
    v_add_u32 v56, 3072, v1
    v_lshlrev_b32 v57, 4, v56
    buffer_load_dwordx4 v[60:63], v57, s[16:19], 0 offen
    v_mul_hi_u32 v57, v56, s34
    v_mul_u32_u24 v58, 72, v57
    v_sub_u32 v58, v56, v58
    v_mul_u32_u24 v59, 3641, v58
    v_lshrrev_b32 v59, 16, v59
    v_mul_u32_u24 v56, 18, v59
    v_sub_u32 v58, v58, v56
    v_mul_u32_u24 v57, 288, v57
    v_lshl_add_u32 v57, v58, 4, v57
    s_mov_b32 s35, 1327104
    v_mul_lo_u32 v59, v59, s35
    v_add_u32 v57, v57, v59
    v_add_u32 v64, 3584, v1
    v_lshlrev_b32 v65, 4, v64
    buffer_load_dwordx4 v[68:71], v65, s[16:19], 0 offen
    v_mul_hi_u32 v65, v64, s34
    v_mul_u32_u24 v66, 72, v65
    v_sub_u32 v66, v64, v66
    v_mul_u32_u24 v67, 3641, v66
    v_lshrrev_b32 v67, 16, v67
    v_mul_u32_u24 v64, 18, v67
    v_sub_u32 v66, v66, v64
    v_mul_u32_u24 v65, 288, v65
    v_lshl_add_u32 v65, v66, 4, v65
    s_mov_b32 s35, 1327104
    v_mul_lo_u32 v67, v67, s35
    v_add_u32 v65, v65, v67
    s_waitcnt vmcnt(0)
    buffer_store_dwordx4 v[12:15], v9, s[20:23], 0 offen
    buffer_store_dwordx4 v[20:23], v17, s[20:23], 0 offen
    buffer_store_dwordx4 v[28:31], v25, s[20:23], 0 offen
    buffer_store_dwordx4 v[36:39], v33, s[20:23], 0 offen
    buffer_store_dwordx4 v[44:47], v41, s[20:23], 0 offen
    buffer_store_dwordx4 v[52:55], v49, s[20:23], 0 offen
    buffer_store_dwordx4 v[60:63], v57, s[20:23], 0 offen
    buffer_store_dwordx4 v[68:71], v65, s[20:23], 0 offen
    v_add_u32 v1, 4096, v1
    s_sub_u32 s41, s41, 1
    s_cmp_lg_u32 s41, 0
    s_cbranch_scc1 L_k1_copy_loop
    v_cmp_gt_u32 vcc, 256, v0
    s_and_saveexec_b64 s[36:37], vcc
    s_cbranch_execz L_k1_done
    v_lshlrev_b32 v9, 4, v1
    buffer_load_dwordx4 v[12:15], v9, s[16:19], 0 offen
    v_mul_hi_u32 v9, v1, s34
    v_mul_u32_u24 v10, 72, v9
    v_sub_u32 v10, v1, v10
    v_mul_u32_u24 v11, 3641, v10
    v_lshrrev_b32 v11, 16, v11
    v_mul_u32_u24 v8, 18, v11
    v_sub_u32 v10, v10, v8
    v_mul_u32_u24 v9, 288, v9
    v_lshl_add_u32 v9, v10, 4, v9
    s_mov_b32 s35, 1327104
    v_mul_lo_u32 v11, v11, s35
    v_add_u32 v9, v9, v11
    s_waitcnt vmcnt(0)
    buffer_store_dwordx4 v[12:15], v9, s[20:23], 0 offen
L_k1_done:
    s_endpgm
.text
.globl gemm2_kernel
.p2align 8
.type gemm2_kernel,@function
gemm2_kernel:
    s_cmp_ge_u32 s2, 256
    s_cbranch_scc1 L_k2_done
    s_load_dwordx4 s[4:7], s[0:1], 8
    s_load_dwordx2 s[8:9], s[0:1], 64
    s_load_dwordx2 s[12:13], s[0:1], 96
    v_lshrrev_b32 v1, 6, v0
    v_and_b32 v2, 63, v0
    s_and_b32 s33, s2, 3
    s_bfe_u32 s34, s2, 0x10002
    s_lshr_b32 s35, s2, 3
    v_readfirstlane_b32 s32, v1
    s_lshr_b32 s36, s35, 2
    s_lshl_b32 s34, s34, 3
    s_add_u32 s34, s34, s36
    s_lshl_b32 s34, s34, 7
    s_and_b32 s35, s35, 3
    s_mul_i32 s35, s35, 144
    s_waitcnt lgkmcnt(0)
    s_cmp_ge_u32 s33, 2
    s_cbranch_scc1 L_k2_mlp
    s_cmp_eq_u32 s33, 1
    s_cselect_b32 s16, s6, s4
    s_cselect_b32 s17, s7, s5
    s_mov_b32 s18, 8388608
    s_mov_b32 s36, 4718592
    s_cselect_b32 s36, 7077888, s36
    s_mul_i32 s37, s35, 4096
    s_add_u32 s36, s36, s37
    s_add_u32 s20, s12, s36
    s_addc_u32 s21, s13, 0
    s_mov_b32 s22, 589824
    s_mov_b32 s46, 4096
    s_mov_b32 s47, 32
    s_branch L_k2_go
L_k2_mlp:
    s_cmp_eq_u32 s33, 3
    s_mov_b32 s36, 9437184
    s_cselect_b32 s36, 9441792, s36
    s_mov_b32 s18, 18874368
    s_cselect_b32 s18, 18869760, s18
    s_mov_b32 s37, 47251456
    s_cselect_b32 s37, 47915008, s37
    s_mov_b32 s22, 663552
    s_add_u32 s16, s12, s36
    s_addc_u32 s17, s13, 0
    s_mul_i32 s36, s35, 9216
    s_add_u32 s37, s37, s36
    s_add_u32 s20, s12, s37
    s_addc_u32 s21, s13, 0
    s_mov_b32 s46, 9216
    s_mov_b32 s47, 36
L_k2_go:
    s_mov_b32 s19, 0x00020000
    s_mov_b32 s23, 0x00020000
    s_mul_i32 s36, s33, 4718592
    s_add_u32 s36, s36, 28311552
    s_add_u32 s24, s12, s36
    s_addc_u32 s25, s13, 0
    s_mov_b32 s26, 4718592
    s_mov_b32 s27, 0x00020000
    s_cmp_ge_u32 s32, 4
    s_cbranch_scc1 L_k2_loader
    s_lshr_b32 s36, s32, 1
    s_and_b32 s37, s32, 1
    v_and_b32 v3, 15, v2
    v_lshrrev_b32 v4, 4, v2
    s_lshl_b32 s38, s37, 2
    v_add_u32 v5, s38, v4
    v_lshrrev_b32 v6, 1, v3
    v_xor_b32 v5, v5, v6
    s_lshl_b32 s38, s36, 6
    v_add_u32 v6, s38, v3
    v_lshlrev_b32 v6, 7, v6
    v_lshl_add_u32 v76, v5, 4, v6
    v_lshrrev_b32 v5, 2, v3
    v_lshl_add_u32 v5, v4, 3, v5
    s_lshl_b32 s38, s37, 5
    v_add_u32 v5, s38, v5
    v_mul_u32_u24 v5, 288, v5
    v_and_b32 v6, 3, v3
    v_lshl_add_u32 v5, v6, 3, v5
    v_add_u32 v79, 16384, v5
    v_and_b32 v6, 1, v4
    v_lshlrev_b32 v6, 7, v6
    v_add_u32 v77, v79, v6
    v_sub_u32 v78, v79, v6
    s_lshr_b32 s49, s2, 3
    s_cmp_eq_u32 s32, 0
    s_cbranch_scc1 L_k2_pfa
    s_cmp_eq_u32 s32, 1
    s_cbranch_scc1 L_k2_pfb
    s_mov_b32 s60, s16
    s_mov_b32 s61, s17
    s_mov_b32 s62, 0
    s_mov_b32 s63, 0x00020000
    v_mov_b32 v81, 0
    s_mov_b32 s65, 0
    s_branch L_k2_pfgo
L_k2_pfa:
    s_mov_b32 s60, s16
    s_mov_b32 s61, s17
    s_mov_b32 s62, s18
    s_mov_b32 s63, 0x00020000
    s_and_b32 s50, s49, 3
    s_lshl_b32 s50, s50, 5
    s_add_u32 s50, s50, s34
    v_and_b32 v5, 31, v2
    v_add_u32 v5, s50, v5
    v_mul_lo_u32 v5, v5, s46
    v_lshrrev_b32 v6, 5, v2
    v_lshl_add_u32 v81, v6, 7, v5
    s_mov_b32 s65, 256
    s_branch L_k2_pfgo
L_k2_pfb:
    s_mov_b32 s60, s20
    s_mov_b32 s61, s21
    s_mov_b32 s62, s22
    s_mov_b32 s63, 0x00020000
    v_mul_u32_u24 v5, 3641, v2
    v_lshrrev_b32 v5, 16, v5
    v_mul_u32_u24 v6, 18, v5
    v_sub_u32 v6, v2, v6
    v_mul_u32_u24 v5, 18432, v5
    v_lshl_add_u32 v81, v6, 7, v5
    s_lshr_b32 s50, s49, 2
    s_mul_i32 s50, s50, 2304
    v_add_u32 v81, s50, v81
    v_mov_b32 v6, 0x7ff00000
    v_cmp_gt_u32 vcc, 36, v2
    s_nop 1
    v_cndmask_b32 v81, v6, v81, vcc
    s_mov_b32 s65, 36864
L_k2_pfgo:
    s_lshl_b32 s64, s65, 1
    buffer_load_dword v80, v81, s[60:63], s64 offen
    s_add_u32 s64, s64, s65
    buffer_load_dword v80, v81, s[60:63], s64 offen
    s_add_u32 s64, s64, s65
    buffer_load_dword v80, v81, s[60:63], s64 offen
    s_add_u32 s64, s64, s65
    v_mov_b32 v112, 0
    v_mov_b32 v113, 0
    v_mov_b32 v114, 0
    v_mov_b32 v115, 0
    v_mov_b32 v116, 0
    v_mov_b32 v117, 0
    v_mov_b32 v118, 0
    v_mov_b32 v119, 0
    v_mov_b32 v120, 0
    v_mov_b32 v121, 0
    v_mov_b32 v122, 0
    v_mov_b32 v123, 0
    v_mov_b32 v124, 0
    v_mov_b32 v125, 0
    v_mov_b32 v126, 0
    v_mov_b32 v127, 0
    v_mov_b32 v128, 0
    v_mov_b32 v129, 0
    v_mov_b32 v130, 0
    v_mov_b32 v131, 0
    v_mov_b32 v132, 0
    v_mov_b32 v133, 0
    v_mov_b32 v134, 0
    v_mov_b32 v135, 0
    v_mov_b32 v136, 0
    v_mov_b32 v137, 0
    v_mov_b32 v138, 0
    v_mov_b32 v139, 0
    v_mov_b32 v140, 0
    v_mov_b32 v141, 0
    v_mov_b32 v142, 0
    v_mov_b32 v143, 0
    v_mov_b32 v144, 0
    v_mov_b32 v145, 0
    v_mov_b32 v146, 0
    v_mov_b32 v147, 0
    v_mov_b32 v148, 0
    v_mov_b32 v149, 0
    v_mov_b32 v150, 0
    v_mov_b32 v151, 0
    v_mov_b32 v152, 0
    v_mov_b32 v153, 0
    v_mov_b32 v154, 0
    v_mov_b32 v155, 0
    v_mov_b32 v156, 0
    v_mov_b32 v157, 0
    v_mov_b32 v158, 0
    v_mov_b32 v159, 0
    v_mov_b32 v160, 0
    v_mov_b32 v161, 0
    v_mov_b32 v162, 0
    v_mov_b32 v163, 0
    v_mov_b32 v164, 0
    v_mov_b32 v165, 0
    v_mov_b32 v166, 0
    v_mov_b32 v167, 0
    v_mov_b32 v168, 0
    v_mov_b32 v169, 0
    v_mov_b32 v170, 0
    v_mov_b32 v171, 0
    v_mov_b32 v172, 0
    v_mov_b32 v173, 0
    v_mov_b32 v174, 0
    v_mov_b32 v175, 0
    v_mov_b32 v176, 0
    v_mov_b32 v177, 0
    v_mov_b32 v178, 0
    v_mov_b32 v179, 0
    v_mov_b32 v180, 0
    v_mov_b32 v181, 0
    v_mov_b32 v182, 0
    v_mov_b32 v183, 0
    v_mov_b32 v184, 0
    v_mov_b32 v185, 0
    v_mov_b32 v186, 0
    v_mov_b32 v187, 0
    v_mov_b32 v188, 0
    v_mov_b32 v189, 0
    v_mov_b32 v190, 0
    v_mov_b32 v191, 0
    v_mov_b32 v192, 0
    v_mov_b32 v193, 0
    v_mov_b32 v194, 0
    v_mov_b32 v195, 0
    v_mov_b32 v196, 0
    v_mov_b32 v197, 0
    v_mov_b32 v198, 0
    v_mov_b32 v199, 0
    v_mov_b32 v200, 0
    v_mov_b32 v201, 0
    v_mov_b32 v202, 0
    v_mov_b32 v203, 0
    v_mov_b32 v204, 0
    v_mov_b32 v205, 0
    v_mov_b32 v206, 0
    v_mov_b32 v207, 0
    v_mov_b32 v208, 0
    v_mov_b32 v209, 0
    v_mov_b32 v210, 0
    v_mov_b32 v211, 0
    v_mov_b32 v212, 0
    v_mov_b32 v213, 0
    v_mov_b32 v214, 0
    v_mov_b32 v215, 0
    v_mov_b32 v216, 0
    v_mov_b32 v217, 0
    v_mov_b32 v218, 0
    v_mov_b32 v219, 0
    v_mov_b32 v220, 0
    v_mov_b32 v221, 0
    v_mov_b32 v222, 0
    v_mov_b32 v223, 0
    v_mov_b32 v224, 0
    v_mov_b32 v225, 0
    v_mov_b32 v226, 0
    v_mov_b32 v227, 0
    v_mov_b32 v228, 0
    v_mov_b32 v229, 0
    v_mov_b32 v230, 0
    v_mov_b32 v231, 0
    v_mov_b32 v232, 0
    v_mov_b32 v233, 0
    v_mov_b32 v234, 0
    v_mov_b32 v235, 0
    v_mov_b32 v236, 0
    v_mov_b32 v237, 0
    v_mov_b32 v238, 0
    v_mov_b32 v239, 0
    v_mov_b32 v240, 0
    v_mov_b32 v241, 0
    v_mov_b32 v242, 0
    v_mov_b32 v243, 0
    v_mov_b32 v244, 0
    v_mov_b32 v245, 0
    v_mov_b32 v246, 0
    v_mov_b32 v247, 0
    v_mov_b32 v248, 0
    v_mov_b32 v249, 0
    v_mov_b32 v250, 0
    v_mov_b32 v251, 0
    v_mov_b32 v252, 0
    v_mov_b32 v253, 0
    v_mov_b32 v254, 0
    v_mov_b32 v255, 0
    s_mov_b32 s40, 0
    s_lshr_b32 s41, s47, 1
    s_barrier
    ds_read_b64_tr_b16 v[40:41], v77 offset:0
    ds_read_b64_tr_b16 v[42:43], v78 offset:1280
    ds_read_b128 v[8:11], v76 offset:0
    ds_read_b64_tr_b16 v[44:45], v77 offset:32
    ds_read_b64_tr_b16 v[46:47], v78 offset:1312
    ds_read_b128 v[12:15], v76 offset:2048
    ds_read_b64_tr_b16 v[48:49], v77 offset:64
    ds_read_b64_tr_b16 v[50:51], v78 offset:1344
    ds_read_b128 v[16:19], v76 offset:4096
    ds_read_b64_tr_b16 v[52:53], v77 offset:96
    ds_read_b64_tr_b16 v[54:55], v78 offset:1376
    ds_read_b128 v[20:23], v76 offset:6144
    ds_read_b64_tr_b16 v[56:57], v78 offset:128
    ds_read_b64_tr_b16 v[58:59], v77 offset:1152
    ds_read_b64_tr_b16 v[60:61], v78 offset:160
    ds_read_b64_tr_b16 v[62:63], v77 offset:1184
    ds_read_b64_tr_b16 v[64:65], v78 offset:192
    ds_read_b64_tr_b16 v[66:67], v77 offset:1216
    ds_read_b64_tr_b16 v[68:69], v78 offset:224
    ds_read_b64_tr_b16 v[70:71], v77 offset:1248
    s_add_u32 s40, s40, 1
    s_cmp_eq_u32 s40, 4
    s_mov_b32 s42, 34816
    s_cselect_b32 s42, -104448, s42
    s_cselect_b32 s40, 0, s40
    v_add_u32 v76, s42, v76
    v_add_u32 v77, s42, v77
    v_add_u32 v78, s42, v78
L_k2_cloop:
    buffer_load_dword v80, v81, s[60:63], s64 offen
    s_add_u32 s64, s64, s65
    s_waitcnt lgkmcnt(8)
    v_mfma_f32_16x16x32_bf16 v[112:115], v[40:43], v[8:11], v[112:115]
    ds_read_b64_tr_b16 v[72:73], v79 offset:256
    v_mfma_f32_16x16x32_bf16 v[148:151], v[40:43], v[12:15], v[148:151]
    ds_read_b64_tr_b16 v[74:75], v79 offset:1408
    v_mfma_f32_16x16x32_bf16 v[184:187], v[40:43], v[16:19], v[184:187]
    v_add_u32 v79, s42, v79
    v_mfma_f32_16x16x32_bf16 v[220:223], v[40:43], v[20:23], v[220:223]
    v_mfma_f32_16x16x32_bf16 v[116:119], v[44:47], v[8:11], v[116:119]
    ds_read_b64_tr_b16 v[40:41], v77 offset:0
    v_mfma_f32_16x16x32_bf16 v[152:155], v[44:47], v[12:15], v[152:155]
    ds_read_b64_tr_b16 v[42:43], v78 offset:1280
    v_mfma_f32_16x16x32_bf16 v[188:191], v[44:47], v[16:19], v[188:191]
    ds_read_b128 v[24:27], v76 offset:0
    v_mfma_f32_16x16x32_bf16 v[224:227], v[44:47], v[20:23], v[224:227]
    v_mfma_f32_16x16x32_bf16 v[120:123], v[48:51], v[8:11], v[120:123]
    ds_read_b64_tr_b16 v[44:45], v77 offset:32
    v_mfma_f32_16x16x32_bf16 v[156:159], v[48:51], v[12:15], v[156:159]
    ds_read_b64_tr_b16 v[46:47], v78 offset:1312
    v_mfma_f32_16x16x32_bf16 v[192:195], v[48:51], v[16:19], v[192:195]
    ds_read_b128 v[28:31], v76 offset:2048
    v_mfma_f32_16x16x32_bf16 v[228:231], v[48:51], v[20:23], v[228:231]
    v_mfma_f32_16x16x32_bf16 v[124:127], v[52:55], v[8:11], v[124:127]
    ds_read_b64_tr_b16 v[48:49], v77 offset:64
    v_mfma_f32_16x16x32_bf16 v[160:163], v[52:55], v[12:15], v[160:163]
    ds_read_b64_tr_b16 v[50:51], v78 offset:1344
    v_mfma_f32_16x16x32_bf16 v[196:199], v[52:55], v[16:19], v[196:199]
    ds_read_b128 v[32:35], v76 offset:4096
    v_mfma_f32_16x16x32_bf16 v[232:235], v[52:55], v[20:23], v[232:235]
    s_waitcnt lgkmcnt(15)
    v_mfma_f32_16x16x32_bf16 v[128:131], v[56:59], v[8:11], v[128:131]
    ds_read_b64_tr_b16 v[52:53], v77 offset:96
    v_mfma_f32_16x16x32_bf16 v[164:167], v[56:59], v[12:15], v[164:167]
    ds_read_b64_tr_b16 v[54:55], v78 offset:1376
    v_mfma_f32_16x16x32_bf16 v[200:203], v[56:59], v[16:19], v[200:203]
    ds_read_b128 v[36:39], v76 offset:6144
    v_mfma_f32_16x16x32_bf16 v[236:239], v[56:59], v[20:23], v[236:239]
    v_mfma_f32_16x16x32_bf16 v[132:135], v[60:63], v[8:11], v[132:135]
    ds_read_b64_tr_b16 v[56:57], v78 offset:128
    v_mfma_f32_16x16x32_bf16 v[168:171], v[60:63], v[12:15], v[168:171]
    ds_read_b64_tr_b16 v[58:59], v77 offset:1152
    v_mfma_f32_16x16x32_bf16 v[204:207], v[60:63], v[16:19], v[204:207]
    v_mfma_f32_16x16x32_bf16 v[240:243], v[60:63], v[20:23], v[240:243]
    s_waitcnt lgkmcnt(15)
    v_mfma_f32_16x16x32_bf16 v[136:139], v[64:67], v[8:11], v[136:139]
    ds_read_b64_tr_b16 v[60:61], v78 offset:160
    v_mfma_f32_16x16x32_bf16 v[172:175], v[64:67], v[12:15], v[172:175]
    ds_read_b64_tr_b16 v[62:63], v77 offset:1184
    v_mfma_f32_16x16x32_bf16 v[208:211], v[64:67], v[16:19], v[208:211]
    v_mfma_f32_16x16x32_bf16 v[244:247], v[64:67], v[20:23], v[244:247]
    v_mfma_f32_16x16x32_bf16 v[140:143], v[68:71], v[8:11], v[140:143]
    ds_read_b64_tr_b16 v[64:65], v78 offset:192
    v_mfma_f32_16x16x32_bf16 v[176:179], v[68:71], v[12:15], v[176:179]
    ds_read_b64_tr_b16 v[66:67], v77 offset:1216
    v_mfma_f32_16x16x32_bf16 v[212:215], v[68:71], v[16:19], v[212:215]
    v_mfma_f32_16x16x32_bf16 v[248:251], v[68:71], v[20:23], v[248:251]
    s_waitcnt lgkmcnt(15)
    v_mfma_f32_16x16x32_bf16 v[144:147], v[72:75], v[8:11], v[144:147]
    ds_read_b64_tr_b16 v[68:69], v78 offset:224
    v_mfma_f32_16x16x32_bf16 v[180:183], v[72:75], v[12:15], v[180:183]
    ds_read_b64_tr_b16 v[70:71], v77 offset:1248
    v_mfma_f32_16x16x32_bf16 v[216:219], v[72:75], v[16:19], v[216:219]
    v_mfma_f32_16x16x32_bf16 v[252:255], v[72:75], v[20:23], v[252:255]
    s_add_u32 s40, s40, 1
    s_cmp_eq_u32 s40, 4
    s_mov_b32 s42, 34816
    s_cselect_b32 s42, -104448, s42
    s_cselect_b32 s40, 0, s40
    v_add_u32 v76, s42, v76
    v_add_u32 v77, s42, v77
    v_add_u32 v78, s42, v78
    s_barrier
    s_waitcnt lgkmcnt(8)
    v_mfma_f32_16x16x32_bf16 v[112:115], v[40:43], v[24:27], v[112:115]
    ds_read_b64_tr_b16 v[72:73], v79 offset:256
    v_mfma_f32_16x16x32_bf16 v[148:151], v[40:43], v[28:31], v[148:151]
    ds_read_b64_tr_b16 v[74:75], v79 offset:1408
    v_mfma_f32_16x16x32_bf16 v[184:187], v[40:43], v[32:35], v[184:187]
    v_add_u32 v79, s42, v79
    v_mfma_f32_16x16x32_bf16 v[220:223], v[40:43], v[36:39], v[220:223]
    v_mfma_f32_16x16x32_bf16 v[116:119], v[44:47], v[24:27], v[116:119]
    ds_read_b64_tr_b16 v[40:41], v77 offset:0
    v_mfma_f32_16x16x32_bf16 v[152:155], v[44:47], v[28:31], v[152:155]
    ds_read_b64_tr_b16 v[42:43], v78 offset:1280
    v_mfma_f32_16x16x32_bf16 v[188:191], v[44:47], v[32:35], v[188:191]
    ds_read_b128 v[8:11], v76 offset:0
    v_mfma_f32_16x16x32_bf16 v[224:227], v[44:47], v[36:39], v[224:227]
    v_mfma_f32_16x16x32_bf16 v[120:123], v[48:51], v[24:27], v[120:123]
    ds_read_b64_tr_b16 v[44:45], v77 offset:32
    v_mfma_f32_16x16x32_bf16 v[156:159], v[48:51], v[28:31], v[156:159]
    ds_read_b64_tr_b16 v[46:47], v78 offset:1312
    v_mfma_f32_16x16x32_bf16 v[192:195], v[48:51], v[32:35], v[192:195]
    ds_read_b128 v[12:15], v76 offset:2048
    v_mfma_f32_16x16x32_bf16 v[228:231], v[48:51], v[36:39], v[228:231]
    v_mfma_f32_16x16x32_bf16 v[124:127], v[52:55], v[24:27], v[124:127]
    ds_read_b64_tr_b16 v[48:49], v77 offset:64
    v_mfma_f32_16x16x32_bf16 v[160:163], v[52:55], v[28:31], v[160:163]
    ds_read_b64_tr_b16 v[50:51], v78 offset:1344
    v_mfma_f32_16x16x32_bf16 v[196:199], v[52:55], v[32:35], v[196:199]
    ds_read_b128 v[16:19], v76 offset:4096
    v_mfma_f32_16x16x32_bf16 v[232:235], v[52:55], v[36:39], v[232:235]
    s_waitcnt lgkmcnt(15)
    v_mfma_f32_16x16x32_bf16 v[128:131], v[56:59], v[24:27], v[128:131]
    ds_read_b64_tr_b16 v[52:53], v77 offset:96
    v_mfma_f32_16x16x32_bf16 v[164:167], v[56:59], v[28:31], v[164:167]
    ds_read_b64_tr_b16 v[54:55], v78 offset:1376
    v_mfma_f32_16x16x32_bf16 v[200:203], v[56:59], v[32:35], v[200:203]
    ds_read_b128 v[20:23], v76 offset:6144
    v_mfma_f32_16x16x32_bf16 v[236:239], v[56:59], v[36:39], v[236:239]
    v_mfma_f32_16x16x32_bf16 v[132:135], v[60:63], v[24:27], v[132:135]
    ds_read_b64_tr_b16 v[56:57], v78 offset:128
    v_mfma_f32_16x16x32_bf16 v[168:171], v[60:63], v[28:31], v[168:171]
    ds_read_b64_tr_b16 v[58:59], v77 offset:1152
    v_mfma_f32_16x16x32_bf16 v[204:207], v[60:63], v[32:35], v[204:207]
    v_mfma_f32_16x16x32_bf16 v[240:243], v[60:63], v[36:39], v[240:243]
    s_waitcnt lgkmcnt(15)
    v_mfma_f32_16x16x32_bf16 v[136:139], v[64:67], v[24:27], v[136:139]
    ds_read_b64_tr_b16 v[60:61], v78 offset:160
    v_mfma_f32_16x16x32_bf16 v[172:175], v[64:67], v[28:31], v[172:175]
    ds_read_b64_tr_b16 v[62:63], v77 offset:1184
    v_mfma_f32_16x16x32_bf16 v[208:211], v[64:67], v[32:35], v[208:211]
    v_mfma_f32_16x16x32_bf16 v[244:247], v[64:67], v[36:39], v[244:247]
    v_mfma_f32_16x16x32_bf16 v[140:143], v[68:71], v[24:27], v[140:143]
    ds_read_b64_tr_b16 v[64:65], v78 offset:192
    v_mfma_f32_16x16x32_bf16 v[176:179], v[68:71], v[28:31], v[176:179]
    ds_read_b64_tr_b16 v[66:67], v77 offset:1216
    v_mfma_f32_16x16x32_bf16 v[212:215], v[68:71], v[32:35], v[212:215]
    v_mfma_f32_16x16x32_bf16 v[248:251], v[68:71], v[36:39], v[248:251]
    s_waitcnt lgkmcnt(15)
    v_mfma_f32_16x16x32_bf16 v[144:147], v[72:75], v[24:27], v[144:147]
    ds_read_b64_tr_b16 v[68:69], v78 offset:224
    v_mfma_f32_16x16x32_bf16 v[180:183], v[72:75], v[28:31], v[180:183]
    ds_read_b64_tr_b16 v[70:71], v77 offset:1248
    v_mfma_f32_16x16x32_bf16 v[216:219], v[72:75], v[32:35], v[216:219]
    v_mfma_f32_16x16x32_bf16 v[252:255], v[72:75], v[36:39], v[252:255]
    s_add_u32 s40, s40, 1
    s_cmp_eq_u32 s40, 4
    s_mov_b32 s42, 34816
    s_cselect_b32 s42, -104448, s42
    s_cselect_b32 s40, 0, s40
    v_add_u32 v76, s42, v76
    v_add_u32 v77, s42, v77
    v_add_u32 v78, s42, v78
    s_sub_u32 s41, s41, 1
    s_cmp_lg_u32 s41, 0
    s_barrier
    s_cbranch_scc1 L_k2_cloop
    s_waitcnt lgkmcnt(0)
    s_nop 15
    v_and_b32 v3, 15, v2
    v_lshrrev_b32 v4, 4, v2
    s_lshl_b32 s38, s36, 6
    v_add_u32 v3, s38, v3
    v_mul_u32_u24 v3, 592, v3
    v_lshl_add_u32 v3, v4, 4, v3
    s_mul_i32 s38, s37, 75776
    v_add_u32 v3, s38, v3
    ds_write_b128 v3, v[112:115] offset:0
    ds_write_b128 v3, v[116:119] offset:64
    ds_write_b128 v3, v[120:123] offset:128
    ds_write_b128 v3, v[124:127] offset:192
    ds_write_b128 v3, v[128:131] offset:256
    ds_write_b128 v3, v[132:135] offset:320
    ds_write_b128 v3, v[136:139] offset:384
    ds_write_b128 v3, v[140:143] offset:448
    ds_write_b128 v3, v[144:147] offset:512
    ds_write_b128 v3, v[148:151] offset:9472
    ds_write_b128 v3, v[152:155] offset:9536
    ds_write_b128 v3, v[156:159] offset:9600
    ds_write_b128 v3, v[160:163] offset:9664
    ds_write_b128 v3, v[164:167] offset:9728
    ds_write_b128 v3, v[168:171] offset:9792
    ds_write_b128 v3, v[172:175] offset:9856
    ds_write_b128 v3, v[176:179] offset:9920
    ds_write_b128 v3, v[180:183] offset:9984
    ds_write_b128 v3, v[184:187] offset:18944
    ds_write_b128 v3, v[188:191] offset:19008
    ds_write_b128 v3, v[192:195] offset:19072
    ds_write_b128 v3, v[196:199] offset:19136
    ds_write_b128 v3, v[200:203] offset:19200
    ds_write_b128 v3, v[204:207] offset:19264
    ds_write_b128 v3, v[208:211] offset:19328
    ds_write_b128 v3, v[212:215] offset:19392
    ds_write_b128 v3, v[216:219] offset:19456
    ds_write_b128 v3, v[220:223] offset:28416
    ds_write_b128 v3, v[224:227] offset:28480
    ds_write_b128 v3, v[228:231] offset:28544
    ds_write_b128 v3, v[232:235] offset:28608
    ds_write_b128 v3, v[236:239] offset:28672
    ds_write_b128 v3, v[240:243] offset:28736
    ds_write_b128 v3, v[244:247] offset:28800
    ds_write_b128 v3, v[248:251] offset:28864
    ds_write_b128 v3, v[252:255] offset:28928
    s_waitcnt lgkmcnt(0)
    s_branch L_k2_epi
L_k2_loader:
    s_sub_u32 s36, s32, 4
    v_lshrrev_b32 v3, 3, v2
    v_and_b32 v4, 7, v2
    v_lshrrev_b32 v5, 4, v2
    v_xor_b32 v4, v4, v5
    s_lshl_b32 s37, s36, 5
    s_add_u32 s37, s37, s34
    v_add_u32 v5, s37, v3
    v_mul_lo_u32 v5, v5, s46
    v_lshl_add_u32 v8, v4, 4, v5
    v_xor_b32 v4, 4, v4
    v_lshl_add_u32 v9, v4, 4, v5
    v_add_u32 v3, 0, v2
    v_mul_u32_u24 v4, 3641, v3
    v_lshrrev_b32 v4, 16, v4
    v_mul_u32_u24 v5, 18, v4
    v_sub_u32 v5, v3, v5
    v_bfe_u32 v6, v4, 2, 1
    v_bfe_u32 v7, v4, 3, 1
    v_xor_b32 v6, v6, v7
    v_lshlrev_b32 v6, 3, v6
    v_xor_b32 v6, v5, v6
    v_cmp_gt_u32 vcc, 16, v5
    s_nop 1
    v_cndmask_b32 v5, v5, v6, vcc
    s_lshl_b32 s37, s36, 4
    v_add_u32 v4, s37, v4
    v_mul_u32_u24 v4, 288, v4
    v_lshl_add_u32 v10, v5, 4, v4
    v_add_u32 v3, 64, v2
    v_mul_u32_u24 v4, 3641, v3
    v_lshrrev_b32 v4, 16, v4
    v_mul_u32_u24 v5, 18, v4
    v_sub_u32 v5, v3, v5
    v_bfe_u32 v6, v4, 2, 1
    v_bfe_u32 v7, v4, 3, 1
    v_xor_b32 v6, v6, v7
    v_lshlrev_b32 v6, 3, v6
    v_xor_b32 v6, v5, v6
    v_cmp_gt_u32 vcc, 16, v5
    s_nop 1
    v_cndmask_b32 v5, v5, v6, vcc
    s_lshl_b32 s37, s36, 4
    v_add_u32 v4, s37, v4
    v_mul_u32_u24 v4, 288, v4
    v_lshl_add_u32 v11, v5, 4, v4
    v_add_u32 v3, 128, v2
    v_mul_u32_u24 v4, 3641, v3
    v_lshrrev_b32 v4, 16, v4
    v_mul_u32_u24 v5, 18, v4
    v_sub_u32 v5, v3, v5
    v_bfe_u32 v6, v4, 2, 1
    v_bfe_u32 v7, v4, 3, 1
    v_xor_b32 v6, v6, v7
    v_lshlrev_b32 v6, 3, v6
    v_xor_b32 v6, v5, v6
    v_cmp_gt_u32 vcc, 16, v5
    s_nop 1
    v_cndmask_b32 v5, v5, v6, vcc
    s_lshl_b32 s37, s36, 4
    v_add_u32 v4, s37, v4
    v_mul_u32_u24 v4, 288, v4
    v_lshl_add_u32 v12, v5, 4, v4
    v_add_u32 v3, 192, v2
    v_mul_u32_u24 v4, 3641, v3
    v_lshrrev_b32 v4, 16, v4
    v_mul_u32_u24 v5, 18, v4
    v_sub_u32 v5, v3, v5
    v_bfe_u32 v6, v4, 2, 1
    v_bfe_u32 v7, v4, 3, 1
    v_xor_b32 v6, v6, v7
    v_lshlrev_b32 v6, 3, v6
    v_xor_b32 v6, v5, v6
    v_cmp_gt_u32 vcc, 16, v5
    s_nop 1
    v_cndmask_b32 v5, v5, v6, vcc
    s_lshl_b32 s37, s36, 4
    v_add_u32 v4, s37, v4
    v_mul_u32_u24 v4, 288, v4
    v_lshl_add_u32 v13, v5, 4, v4
    v_add_u32 v3, 256, v2
    v_mul_u32_u24 v4, 3641, v3
    v_lshrrev_b32 v4, 16, v4
    v_mul_u32_u24 v5, 18, v4
    v_sub_u32 v5, v3, v5
    v_bfe_u32 v6, v4, 2, 1
    v_bfe_u32 v7, v4, 3, 1
    v_xor_b32 v6, v6, v7
    v_lshlrev_b32 v6, 3, v6
    v_xor_b32 v6, v5, v6
    v_cmp_gt_u32 vcc, 16, v5
    s_nop 1
    v_cndmask_b32 v5, v5, v6, vcc
    s_lshl_b32 s37, s36, 4
    v_add_u32 v4, s37, v4
    v_mul_u32_u24 v4, 288, v4
    v_lshl_add_u32 v14, v5, 4, v4
    s_lshl_b32 s38, s36, 12
    s_mul_i32 s39, s36, 4608
    s_add_u32 s39, s39, 16384
    s_mov_b32 s40, 0
    s_mov_b32 s43, 0
    s_mov_b32 s44, 0
    s_lshl_b32 s48, s46, 3
    s_add_u32 m0, s38, 0
    s_mov_b32 s45, s43
    buffer_load_dwordx4 v8, s[16:19], s45 offen lds
    s_add_u32 m0, s38, 1024
    s_add_u32 s45, s45, s48
    buffer_load_dwordx4 v9, s[16:19], s45 offen lds
    s_add_u32 m0, s38, 2048
    s_add_u32 s45, s45, s48
    buffer_load_dwordx4 v8, s[16:19], s45 offen lds
    s_add_u32 m0, s38, 3072
    s_add_u32 s45, s45, s48
    buffer_load_dwordx4 v9, s[16:19], s45 offen lds
    s_add_u32 m0, s39, 0
    s_nop 0
    buffer_load_dwordx4 v10, s[20:23], s44 offen lds
    s_add_u32 m0, s39, 1024
    s_nop 0
    buffer_load_dwordx4 v11, s[20:23], s44 offen lds
    s_add_u32 m0, s39, 2048
    s_nop 0
    buffer_load_dwordx4 v12, s[20:23], s44 offen lds
    s_add_u32 m0, s39, 3072
    s_nop 0
    buffer_load_dwordx4 v13, s[20:23], s44 offen lds
    s_add_u32 m0, s39, 4096
    s_mov_b64 exec, 0xffffffff
    buffer_load_dwordx4 v14, s[20:23], s44 offen lds
    s_mov_b64 exec, -1
    s_add_u32 s43, s43, 128
    s_add_u32 s44, s44, 18432
    s_add_u32 s40, s40, 1
    s_cmp_eq_u32 s40, 4
    s_mov_b32 s42, 34816
    s_cselect_b32 s42, -104448, s42
    s_cselect_b32 s40, 0, s40
    s_add_u32 s38, s38, s42
    s_add_u32 s39, s39, s42
    s_add_u32 m0, s38, 0
    s_mov_b32 s45, s43
    buffer_load_dwordx4 v8, s[16:19], s45 offen lds
    s_add_u32 m0, s38, 1024
    s_add_u32 s45, s45, s48
    buffer_load_dwordx4 v9, s[16:19], s45 offen lds
    s_add_u32 m0, s38, 2048
    s_add_u32 s45, s45, s48
    buffer_load_dwordx4 v8, s[16:19], s45 offen lds
    s_add_u32 m0, s38, 3072
    s_add_u32 s45, s45, s48
    buffer_load_dwordx4 v9, s[16:19], s45 offen lds
    s_add_u32 m0, s39, 0
    s_nop 0
    buffer_load_dwordx4 v10, s[20:23], s44 offen lds
    s_add_u32 m0, s39, 1024
    s_nop 0
    buffer_load_dwordx4 v11, s[20:23], s44 offen lds
    s_add_u32 m0, s39, 2048
    s_nop 0
    buffer_load_dwordx4 v12, s[20:23], s44 offen lds
    s_add_u32 m0, s39, 3072
    s_nop 0
    buffer_load_dwordx4 v13, s[20:23], s44 offen lds
    s_add_u32 m0, s39, 4096
    s_mov_b64 exec, 0xffffffff
    buffer_load_dwordx4 v14, s[20:23], s44 offen lds
    s_mov_b64 exec, -1
    s_add_u32 s43, s43, 128
    s_add_u32 s44, s44, 18432
    s_add_u32 s40, s40, 1
    s_cmp_eq_u32 s40, 4
    s_mov_b32 s42, 34816
    s_cselect_b32 s42, -104448, s42
    s_cselect_b32 s40, 0, s40
    s_add_u32 s38, s38, s42
    s_add_u32 s39, s39, s42
    s_add_u32 m0, s38, 0
    s_mov_b32 s45, s43
    buffer_load_dwordx4 v8, s[16:19], s45 offen lds
    s_add_u32 m0, s38, 1024
    s_add_u32 s45, s45, s48
    buffer_load_dwordx4 v9, s[16:19], s45 offen lds
    s_add_u32 m0, s38, 2048
    s_add_u32 s45, s45, s48
    buffer_load_dwordx4 v8, s[16:19], s45 offen lds
    s_add_u32 m0, s38, 3072
    s_add_u32 s45, s45, s48
    buffer_load_dwordx4 v9, s[16:19], s45 offen lds
    s_add_u32 m0, s39, 0
    s_nop 0
    buffer_load_dwordx4 v10, s[20:23], s44 offen lds
    s_add_u32 m0, s39, 1024
    s_nop 0
    buffer_load_dwordx4 v11, s[20:23], s44 offen lds
    s_add_u32 m0, s39, 2048
    s_nop 0
    buffer_load_dwordx4 v12, s[20:23], s44 offen lds
    s_add_u32 m0, s39, 3072
    s_nop 0
    buffer_load_dwordx4 v13, s[20:23], s44 offen lds
    s_add_u32 m0, s39, 4096
    s_mov_b64 exec, 0xffffffff
    buffer_load_dwordx4 v14, s[20:23], s44 offen lds
    s_mov_b64 exec, -1
    s_add_u32 s43, s43, 128
    s_add_u32 s44, s44, 18432
    s_add_u32 s40, s40, 1
    s_cmp_eq_u32 s40, 4
    s_mov_b32 s42, 34816
    s_cselect_b32 s42, -104448, s42
    s_cselect_b32 s40, 0, s40
    s_add_u32 s38, s38, s42
    s_add_u32 s39, s39, s42
    s_waitcnt vmcnt(9)
    s_barrier
    s_sub_u32 s41, s47, 3
L_k2_lloop:
    s_add_u32 m0, s38, 0
    s_mov_b32 s45, s43
    buffer_load_dwordx4 v8, s[16:19], s45 offen lds
    s_add_u32 m0, s38, 1024
    s_add_u32 s45, s45, s48
    buffer_load_dwordx4 v9, s[16:19], s45 offen lds
    s_add_u32 m0, s38, 2048
    s_add_u32 s45, s45, s48
    buffer_load_dwordx4 v8, s[16:19], s45 offen lds
    s_add_u32 m0, s38, 3072
    s_add_u32 s45, s45, s48
    buffer_load_dwordx4 v9, s[16:19], s45 offen lds
    s_add_u32 m0, s39, 0
    s_nop 0
    buffer_load_dwordx4 v10, s[20:23], s44 offen lds
    s_add_u32 m0, s39, 1024
    s_nop 0
    buffer_load_dwordx4 v11, s[20:23], s44 offen lds
    s_add_u32 m0, s39, 2048
    s_nop 0
    buffer_load_dwordx4 v12, s[20:23], s44 offen lds
    s_add_u32 m0, s39, 3072
    s_nop 0
    buffer_load_dwordx4 v13, s[20:23], s44 offen lds
    s_add_u32 m0, s39, 4096
    s_mov_b64 exec, 0xffffffff
    buffer_load_dwordx4 v14, s[20:23], s44 offen lds
    s_mov_b64 exec, -1
    s_add_u32 s43, s43, 128
    s_add_u32 s44, s44, 18432
    s_add_u32 s40, s40, 1
    s_cmp_eq_u32 s40, 4
    s_mov_b32 s42, 34816
    s_cselect_b32 s42, -104448, s42
    s_cselect_b32 s40, 0, s40
    s_add_u32 s38, s38, s42
    s_add_u32 s39, s39, s42
    s_waitcnt vmcnt(9)
    s_barrier
    s_sub_u32 s41, s41, 1
    s_cmp_lg_u32 s41, 0
    s_cbranch_scc1 L_k2_lloop
    s_waitcnt vmcnt(0)
    s_barrier
    s_barrier
    s_barrier
L_k2_epi:
    s_load_dwordx2 s[4:5], s[0:1], 0
    s_load_dwordx4 s[8:11], s[0:1], 72
    s_barrier
    s_mov_b32 s38, 58255
    s_lshl_b32 s49, s33, 5
    v_mov_b32 v7, 0x3fffffff
    s_cmp_ge_u32 s33, 2
    s_cbranch_scc1 L_k2_pubf
    v_add_u32 v8, 0, v0
    v_mul_lo_u32 v9, v8, s38
    v_lshrrev_b32 v9, 21, v9
    v_mul_u32_u24 v10, 36, v9
    v_sub_u32 v10, v8, v10
    v_add_u32 v11, 32, v9
    v_cmp_gt_u32 vcc, s49, v9
    s_nop 1
    v_cndmask_b32 v9, v11, v9, vcc
    v_mul_u32_u24 v11, 592, v9
    v_lshl_add_u32 v11, v10, 4, v11
    ds_read_b128 v[12:15], v11
    v_add_u32 v11, 75776, v11
    ds_read_b128 v[16:19], v11
    v_add_u32 v9, s34, v9
    v_mul_u32_u24 v9, 576, v9
    v_lshl_add_u32 v9, v10, 2, v9
    v_add_u32 v9, s35, v9
    v_lshlrev_b32 v9, 1, v9
    v_add_u32 v20, 512, v0
    v_mul_lo_u32 v21, v20, s38
    v_lshrrev_b32 v21, 21, v21
    v_mul_u32_u24 v22, 36, v21
    v_sub_u32 v22, v20, v22
    v_add_u32 v23, 32, v21
    v_cmp_gt_u32 vcc, s49, v21
    s_nop 1
    v_cndmask_b32 v21, v23, v21, vcc
    v_mul_u32_u24 v23, 592, v21
    v_lshl_add_u32 v23, v22, 4, v23
    ds_read_b128 v[24:27], v23
    v_add_u32 v23, 75776, v23
    ds_read_b128 v[28:31], v23
    v_add_u32 v21, s34, v21
    v_mul_u32_u24 v21, 576, v21
    v_lshl_add_u32 v21, v22, 2, v21
    v_add_u32 v21, s35, v21
    v_lshlrev_b32 v21, 1, v21
    v_add_u32 v32, 1024, v0
    v_mul_lo_u32 v33, v32, s38
    v_lshrrev_b32 v33, 21, v33
    v_mul_u32_u24 v34, 36, v33
    v_sub_u32 v34, v32, v34
    v_add_u32 v35, 32, v33
    v_cmp_gt_u32 vcc, s49, v33
    s_nop 1
    v_cndmask_b32 v33, v35, v33, vcc
    v_mul_u32_u24 v35, 592, v33
    v_lshl_add_u32 v35, v34, 4, v35
    ds_read_b128 v[36:39], v35
    v_add_u32 v35, 75776, v35
    ds_read_b128 v[40:43], v35
    v_add_u32 v33, s34, v33
    v_mul_u32_u24 v33, 576, v33
    v_lshl_add_u32 v33, v34, 2, v33
    v_add_u32 v33, s35, v33
    v_lshlrev_b32 v33, 1, v33
    v_add_u32 v44, 1536, v0
    v_mul_lo_u32 v45, v44, s38
    v_lshrrev_b32 v45, 21, v45
    v_mul_u32_u24 v46, 36, v45
    v_sub_u32 v46, v44, v46
    v_add_u32 v47, 32, v45
    v_cmp_gt_u32 vcc, s49, v45
    s_nop 1
    v_cndmask_b32 v45, v47, v45, vcc
    v_mul_u32_u24 v47, 592, v45
    v_lshl_add_u32 v47, v46, 4, v47
    ds_read_b128 v[48:51], v47
    v_add_u32 v47, 75776, v47
    ds_read_b128 v[52:55], v47
    v_add_u32 v45, s34, v45
    v_mul_u32_u24 v45, 576, v45
    v_lshl_add_u32 v45, v46, 2, v45
    v_add_u32 v45, s35, v45
    v_lshlrev_b32 v45, 1, v45
    s_waitcnt lgkmcnt(6)
    v_add_f32 v12, v12, v16
    v_add_f32 v13, v13, v17
    v_add_f32 v14, v14, v18
    v_add_f32 v15, v15, v19
    v_cvt_pk_bf16_f32 v12, v12, v13
    v_cvt_pk_bf16_f32 v13, v14, v15
    buffer_store_dwordx2 v[12:13], v9, s[24:27], 0 offen sc1
    s_waitcnt lgkmcnt(4)
    v_add_f32 v24, v24, v28
    v_add_f32 v25, v25, v29
    v_add_f32 v26, v26, v30
    v_add_f32 v27, v27, v31
    v_cvt_pk_bf16_f32 v24, v24, v25
    v_cvt_pk_bf16_f32 v25, v26, v27
    buffer_store_dwordx2 v[24:25], v21, s[24:27], 0 offen sc1
    s_waitcnt lgkmcnt(2)
    v_add_f32 v36, v36, v40
    v_add_f32 v37, v37, v41
    v_add_f32 v38, v38, v42
    v_add_f32 v39, v39, v43
    v_cvt_pk_bf16_f32 v36, v36, v37
    v_cvt_pk_bf16_f32 v37, v38, v39
    buffer_store_dwordx2 v[36:37], v33, s[24:27], 0 offen sc1
    s_waitcnt lgkmcnt(0)
    v_add_f32 v48, v48, v52
    v_add_f32 v49, v49, v53
    v_add_f32 v50, v50, v54
    v_add_f32 v51, v51, v55
    v_cvt_pk_bf16_f32 v48, v48, v49
    v_cvt_pk_bf16_f32 v49, v50, v51
    buffer_store_dwordx2 v[48:49], v45, s[24:27], 0 offen sc1
    s_nop 1
    v_add_u32 v8, 2048, v0
    v_mul_lo_u32 v9, v8, s38
    v_lshrrev_b32 v9, 21, v9
    v_mul_u32_u24 v10, 36, v9
    v_sub_u32 v10, v8, v10
    v_add_u32 v11, 32, v9
    v_cmp_gt_u32 vcc, s49, v9
    s_nop 1
    v_cndmask_b32 v9, v11, v9, vcc
    v_mul_u32_u24 v11, 592, v9
    v_lshl_add_u32 v11, v10, 4, v11
    ds_read_b128 v[12:15], v11
    v_add_u32 v11, 75776, v11
    ds_read_b128 v[16:19], v11
    v_add_u32 v9, s34, v9
    v_mul_u32_u24 v9, 576, v9
    v_lshl_add_u32 v9, v10, 2, v9
    v_add_u32 v9, s35, v9
    v_lshlrev_b32 v9, 1, v9
    v_add_u32 v20, 2560, v0
    v_mul_lo_u32 v21, v20, s38
    v_lshrrev_b32 v21, 21, v21
    v_mul_u32_u24 v22, 36, v21
    v_sub_u32 v22, v20, v22
    v_add_u32 v23, 32, v21
    v_cmp_gt_u32 vcc, s49, v21
    s_nop 1
    v_cndmask_b32 v21, v23, v21, vcc
    v_mul_u32_u24 v23, 592, v21
    v_lshl_add_u32 v23, v22, 4, v23
    ds_read_b128 v[24:27], v23
    v_add_u32 v23, 75776, v23
    ds_read_b128 v[28:31], v23
    v_add_u32 v21, s34, v21
    v_mul_u32_u24 v21, 576, v21
    v_lshl_add_u32 v21, v22, 2, v21
    v_add_u32 v21, s35, v21
    v_lshlrev_b32 v21, 1, v21
    v_add_u32 v32, 3072, v0
    v_mul_lo_u32 v33, v32, s38
    v_lshrrev_b32 v33, 21, v33
    v_mul_u32_u24 v34, 36, v33
    v_sub_u32 v34, v32, v34
    v_add_u32 v35, 32, v33
    v_cmp_gt_u32 vcc, s49, v33
    s_nop 1
    v_cndmask_b32 v33, v35, v33, vcc
    v_mul_u32_u24 v35, 592, v33
    v_lshl_add_u32 v35, v34, 4, v35
    ds_read_b128 v[36:39], v35
    v_add_u32 v35, 75776, v35
    ds_read_b128 v[40:43], v35
    v_add_u32 v33, s34, v33
    v_mul_u32_u24 v33, 576, v33
    v_lshl_add_u32 v33, v34, 2, v33
    v_add_u32 v33, s35, v33
    v_cmp_gt_u32 vcc, 3456, v32
    s_nop 1
    v_cndmask_b32 v33, v7, v33, vcc
    v_lshlrev_b32 v33, 1, v33
    s_waitcnt lgkmcnt(4)
    v_add_f32 v12, v12, v16
    v_add_f32 v13, v13, v17
    v_add_f32 v14, v14, v18
    v_add_f32 v15, v15, v19
    v_cvt_pk_bf16_f32 v12, v12, v13
    v_cvt_pk_bf16_f32 v13, v14, v15
    buffer_store_dwordx2 v[12:13], v9, s[24:27], 0 offen sc1
    s_waitcnt lgkmcnt(2)
    v_add_f32 v24, v24, v28
    v_add_f32 v25, v25, v29
    v_add_f32 v26, v26, v30
    v_add_f32 v27, v27, v31
    v_cvt_pk_bf16_f32 v24, v24, v25
    v_cvt_pk_bf16_f32 v25, v26, v27
    buffer_store_dwordx2 v[24:25], v21, s[24:27], 0 offen sc1
    s_waitcnt lgkmcnt(0)
    v_add_f32 v36, v36, v40
    v_add_f32 v37, v37, v41
    v_add_f32 v38, v38, v42
    v_add_f32 v39, v39, v43
    v_cvt_pk_bf16_f32 v36, v36, v37
    v_cvt_pk_bf16_f32 v37, v38, v39
    buffer_store_dwordx2 v[36:37], v33, s[24:27], 0 offen sc1
    s_nop 1
    s_branch L_k2_pubd
L_k2_pubf:
    v_add_u32 v8, 0, v0
    v_mul_lo_u32 v9, v8, s38
    v_lshrrev_b32 v9, 21, v9
    v_mul_u32_u24 v10, 36, v9
    v_sub_u32 v10, v8, v10
    v_add_u32 v11, 32, v9
    v_cmp_gt_u32 vcc, s49, v9
    s_nop 1
    v_cndmask_b32 v9, v11, v9, vcc
    v_mul_u32_u24 v11, 592, v9
    v_lshl_add_u32 v11, v10, 4, v11
    ds_read_b128 v[12:15], v11
    v_add_u32 v11, 75776, v11
    ds_read_b128 v[16:19], v11
    v_add_u32 v9, s34, v9
    v_mul_u32_u24 v9, 576, v9
    v_lshl_add_u32 v9, v10, 2, v9
    v_add_u32 v9, s35, v9
    v_lshlrev_b32 v9, 2, v9
    v_add_u32 v20, 512, v0
    v_mul_lo_u32 v21, v20, s38
    v_lshrrev_b32 v21, 21, v21
    v_mul_u32_u24 v22, 36, v21
    v_sub_u32 v22, v20, v22
    v_add_u32 v23, 32, v21
    v_cmp_gt_u32 vcc, s49, v21
    s_nop 1
    v_cndmask_b32 v21, v23, v21, vcc
    v_mul_u32_u24 v23, 592, v21
    v_lshl_add_u32 v23, v22, 4, v23
    ds_read_b128 v[24:27], v23
    v_add_u32 v23, 75776, v23
    ds_read_b128 v[28:31], v23
    v_add_u32 v21, s34, v21
    v_mul_u32_u24 v21, 576, v21
    v_lshl_add_u32 v21, v22, 2, v21
    v_add_u32 v21, s35, v21
    v_lshlrev_b32 v21, 2, v21
    v_add_u32 v32, 1024, v0
    v_mul_lo_u32 v33, v32, s38
    v_lshrrev_b32 v33, 21, v33
    v_mul_u32_u24 v34, 36, v33
    v_sub_u32 v34, v32, v34
    v_add_u32 v35, 32, v33
    v_cmp_gt_u32 vcc, s49, v33
    s_nop 1
    v_cndmask_b32 v33, v35, v33, vcc
    v_mul_u32_u24 v35, 592, v33
    v_lshl_add_u32 v35, v34, 4, v35
    ds_read_b128 v[36:39], v35
    v_add_u32 v35, 75776, v35
    ds_read_b128 v[40:43], v35
    v_add_u32 v33, s34, v33
    v_mul_u32_u24 v33, 576, v33
    v_lshl_add_u32 v33, v34, 2, v33
    v_add_u32 v33, s35, v33
    v_lshlrev_b32 v33, 2, v33
    v_add_u32 v44, 1536, v0
    v_mul_lo_u32 v45, v44, s38
    v_lshrrev_b32 v45, 21, v45
    v_mul_u32_u24 v46, 36, v45
    v_sub_u32 v46, v44, v46
    v_add_u32 v47, 32, v45
    v_cmp_gt_u32 vcc, s49, v45
    s_nop 1
    v_cndmask_b32 v45, v47, v45, vcc
    v_mul_u32_u24 v47, 592, v45
    v_lshl_add_u32 v47, v46, 4, v47
    ds_read_b128 v[48:51], v47
    v_add_u32 v47, 75776, v47
    ds_read_b128 v[52:55], v47
    v_add_u32 v45, s34, v45
    v_mul_u32_u24 v45, 576, v45
    v_lshl_add_u32 v45, v46, 2, v45
    v_add_u32 v45, s35, v45
    v_lshlrev_b32 v45, 2, v45
    s_waitcnt lgkmcnt(6)
    v_add_f32 v12, v12, v16
    v_add_f32 v13, v13, v17
    v_add_f32 v14, v14, v18
    v_add_f32 v15, v15, v19
    buffer_store_dwordx4 v[12:15], v9, s[24:27], 0 offen sc1
    s_waitcnt lgkmcnt(4)
    v_add_f32 v24, v24, v28
    v_add_f32 v25, v25, v29
    v_add_f32 v26, v26, v30
    v_add_f32 v27, v27, v31
    buffer_store_dwordx4 v[24:27], v21, s[24:27], 0 offen sc1
    s_waitcnt lgkmcnt(2)
    v_add_f32 v36, v36, v40
    v_add_f32 v37, v37, v41
    v_add_f32 v38, v38, v42
    v_add_f32 v39, v39, v43
    buffer_store_dwordx4 v[36:39], v33, s[24:27], 0 offen sc1
    s_waitcnt lgkmcnt(0)
    v_add_f32 v48, v48, v52
    v_add_f32 v49, v49, v53
    v_add_f32 v50, v50, v54
    v_add_f32 v51, v51, v55
    buffer_store_dwordx4 v[48:51], v45, s[24:27], 0 offen sc1
    s_nop 1
    v_add_u32 v8, 2048, v0
    v_mul_lo_u32 v9, v8, s38
    v_lshrrev_b32 v9, 21, v9
    v_mul_u32_u24 v10, 36, v9
    v_sub_u32 v10, v8, v10
    v_add_u32 v11, 32, v9
    v_cmp_gt_u32 vcc, s49, v9
    s_nop 1
    v_cndmask_b32 v9, v11, v9, vcc
    v_mul_u32_u24 v11, 592, v9
    v_lshl_add_u32 v11, v10, 4, v11
    ds_read_b128 v[12:15], v11
    v_add_u32 v11, 75776, v11
    ds_read_b128 v[16:19], v11
    v_add_u32 v9, s34, v9
    v_mul_u32_u24 v9, 576, v9
    v_lshl_add_u32 v9, v10, 2, v9
    v_add_u32 v9, s35, v9
    v_lshlrev_b32 v9, 2, v9
    v_add_u32 v20, 2560, v0
    v_mul_lo_u32 v21, v20, s38
    v_lshrrev_b32 v21, 21, v21
    v_mul_u32_u24 v22, 36, v21
    v_sub_u32 v22, v20, v22
    v_add_u32 v23, 32, v21
    v_cmp_gt_u32 vcc, s49, v21
    s_nop 1
    v_cndmask_b32 v21, v23, v21, vcc
    v_mul_u32_u24 v23, 592, v21
    v_lshl_add_u32 v23, v22, 4, v23
    ds_read_b128 v[24:27], v23
    v_add_u32 v23, 75776, v23
    ds_read_b128 v[28:31], v23
    v_add_u32 v21, s34, v21
    v_mul_u32_u24 v21, 576, v21
    v_lshl_add_u32 v21, v22, 2, v21
    v_add_u32 v21, s35, v21
    v_lshlrev_b32 v21, 2, v21
    v_add_u32 v32, 3072, v0
    v_mul_lo_u32 v33, v32, s38
    v_lshrrev_b32 v33, 21, v33
    v_mul_u32_u24 v34, 36, v33
    v_sub_u32 v34, v32, v34
    v_add_u32 v35, 32, v33
    v_cmp_gt_u32 vcc, s49, v33
    s_nop 1
    v_cndmask_b32 v33, v35, v33, vcc
    v_mul_u32_u24 v35, 592, v33
    v_lshl_add_u32 v35, v34, 4, v35
    ds_read_b128 v[36:39], v35
    v_add_u32 v35, 75776, v35
    ds_read_b128 v[40:43], v35
    v_add_u32 v33, s34, v33
    v_mul_u32_u24 v33, 576, v33
    v_lshl_add_u32 v33, v34, 2, v33
    v_add_u32 v33, s35, v33
    v_cmp_gt_u32 vcc, 3456, v32
    s_nop 1
    v_cndmask_b32 v33, v7, v33, vcc
    v_lshlrev_b32 v33, 2, v33
    s_waitcnt lgkmcnt(4)
    v_add_f32 v12, v12, v16
    v_add_f32 v13, v13, v17
    v_add_f32 v14, v14, v18
    v_add_f32 v15, v15, v19
    buffer_store_dwordx4 v[12:15], v9, s[24:27], 0 offen sc1
    s_waitcnt lgkmcnt(2)
    v_add_f32 v24, v24, v28
    v_add_f32 v25, v25, v29
    v_add_f32 v26, v26, v30
    v_add_f32 v27, v27, v31
    buffer_store_dwordx4 v[24:27], v21, s[24:27], 0 offen sc1
    s_waitcnt lgkmcnt(0)
    v_add_f32 v36, v36, v40
    v_add_f32 v37, v37, v41
    v_add_f32 v38, v38, v42
    v_add_f32 v39, v39, v43
    buffer_store_dwordx4 v[36:39], v33, s[24:27], 0 offen sc1
    s_nop 1
L_k2_pubd:
    s_waitcnt vmcnt(0) lgkmcnt(0)
    s_barrier
    s_mov_b32 s52, s4
    s_mov_b32 s53, s5
    s_mov_b32 s54, 2359296
    s_mov_b32 s55, 0x00020000
    s_mov_b32 s56, s8
    s_mov_b32 s57, s9
    s_mov_b32 s58, 1152
    s_mov_b32 s59, 0x00020000
    s_mov_b32 s60, s10
    s_mov_b32 s61, s11
    s_mov_b32 s62, 2359296
    s_mov_b32 s63, 0x00020000
    s_add_u32 s64, s12, 47185920
    s_addc_u32 s65, s13, 0
    s_mov_b32 s66, 8192
    s_mov_b32 s67, 0x00020000
    s_add_u32 s68, s12, 28311552
    s_addc_u32 s69, s13, 0
    s_mov_b32 s70, 18874368
    s_mov_b32 s71, 0x00020000
    s_lshr_b32 s39, s34, 5
    s_lshr_b32 s40, s2, 3
    s_and_b32 s40, s40, 3
    s_add_u32 s39, s39, s40
    s_lshl_b32 s39, s39, 7
    v_mov_b32 v200, 1
    s_lshl_b32 s40, s33, 2
    s_add_u32 s40, s40, s39
    v_mov_b32 v201, s40
    v_mov_b32 v202, s39
    s_cmp_lg_u32 s32, 0
    s_cbranch_scc1 L_k2_nosig
    s_mov_b64 exec, 1
    buffer_store_dword v200, v201, s[64:67], 0 offen sc1
    s_mov_b64 exec, -1
L_k2_nosig:
    v_add_u32 v8, 0, v0
    v_mul_lo_u32 v9, v8, s38
    v_lshrrev_b32 v9, 21, v9
    v_mul_u32_u24 v10, 36, v9
    v_sub_u32 v10, v8, v10
    v_add_u32 v9, s49, v9
    v_mul_u32_u24 v11, 592, v9
    v_lshl_add_u32 v11, v10, 4, v11
    v_add_u32 v9, s34, v9
    v_mul_u32_u24 v9, 576, v9
    v_lshl_add_u32 v9, v10, 2, v9
    v_add_u32 v9, s35, v9
    v_lshlrev_b32 v12, 1, v9
    v_lshlrev_b32 v13, 2, v9
    v_lshlrev_b32 v10, 3, v10
    s_lshl_b32 s40, s35, 1
    buffer_load_dwordx2 v[14:15], v12, s[52:55], 0 offen
    buffer_load_dwordx2 v[16:17], v10, s[56:59], s40 offen
    ds_read_b128 v[20:23], v11
    v_add_u32 v11, 75776, v11
    ds_read_b128 v[24:27], v11
    v_add_u32 v48, 512, v0
    v_mul_lo_u32 v49, v48, s38
    v_lshrrev_b32 v49, 21, v49
    v_mul_u32_u24 v50, 36, v49
    v_sub_u32 v50, v48, v50
    v_add_u32 v49, s49, v49
    v_mul_u32_u24 v51, 592, v49
    v_lshl_add_u32 v51, v50, 4, v51
    v_add_u32 v49, s34, v49
    v_mul_u32_u24 v49, 576, v49
    v_lshl_add_u32 v49, v50, 2, v49
    v_add_u32 v49, s35, v49
    v_lshlrev_b32 v52, 1, v49
    v_lshlrev_b32 v53, 2, v49
    v_lshlrev_b32 v50, 3, v50
    s_lshl_b32 s40, s35, 1
    buffer_load_dwordx2 v[54:55], v52, s[52:55], 0 offen
    buffer_load_dwordx2 v[56:57], v50, s[56:59], s40 offen
    ds_read_b128 v[60:63], v51
    v_add_u32 v51, 75776, v51
    ds_read_b128 v[64:67], v51
    v_add_u32 v88, 1024, v0
    v_mul_lo_u32 v89, v88, s38
    v_lshrrev_b32 v89, 21, v89
    v_mul_u32_u24 v90, 36, v89
    v_sub_u32 v90, v88, v90
    v_add_u32 v89, s49, v89
    v_mul_u32_u24 v91, 592, v89
    v_lshl_add_u32 v91, v90, 4, v91
    v_add_u32 v89, s34, v89
    v_mul_u32_u24 v89, 576, v89
    v_lshl_add_u32 v89, v90, 2, v89
    v_add_u32 v89, s35, v89
    v_cmp_gt_u32 vcc, 1152, v88
    s_nop 1
    v_cndmask_b32 v89, v7, v89, vcc
    v_mov_b32 v92, 0
    v_cndmask_b32 v91, v92, v91, vcc
    v_lshlrev_b32 v92, 1, v89
    v_lshlrev_b32 v93, 2, v89
    v_lshlrev_b32 v90, 3, v90
    s_lshl_b32 s40, s35, 1
    buffer_load_dwordx2 v[94:95], v92, s[52:55], 0 offen
    buffer_load_dwordx2 v[96:97], v90, s[56:59], s40 offen
    ds_read_b128 v[100:103], v91
    v_add_u32 v91, 75776, v91
    ds_read_b128 v[104:107], v91
    s_cmp_lg_u32 s32, 0
    s_cbranch_scc1 L_k2_wait
    s_mov_b64 exec, 1
L_k2_poll:
    buffer_load_dwordx4 v[204:207], v202, s[64:67], 0 offen sc1
    s_waitcnt vmcnt(0)
    v_and_b32 v204, v204, v205
    v_and_b32 v206, v206, v207
    v_and_b32 v204, v204, v206
    s_nop 0
    v_readfirstlane_b32 s40, v204
    s_cmp_eq_u32 s40, 1
    s_cbranch_scc1 L_k2_polldone
    s_sleep 1
    s_branch L_k2_poll
L_k2_polldone:
    s_mov_b64 exec, -1
L_k2_wait:
    s_barrier
    s_mov_b32 s39, 0
    buffer_load_dwordx2 v[28:29], v12, s[68:71], s39 offen sc1
    s_mov_b32 s39, 4718592
    buffer_load_dwordx2 v[32:33], v12, s[68:71], s39 offen sc1
    s_mov_b32 s39, 9437184
    buffer_load_dwordx4 v[36:39], v13, s[68:71], s39 offen sc1
    s_mov_b32 s39, 14155776
    buffer_load_dwordx4 v[40:43], v13, s[68:71], s39 offen sc1
    s_mov_b32 s39, 0
    buffer_load_dwordx2 v[68:69], v52, s[68:71], s39 offen sc1
    s_mov_b32 s39, 4718592
    buffer_load_dwordx2 v[72:73], v52, s[68:71], s39 offen sc1
    s_mov_b32 s39, 9437184
    buffer_load_dwordx4 v[76:79], v53, s[68:71], s39 offen sc1
    s_mov_b32 s39, 14155776
    buffer_load_dwordx4 v[80:83], v53, s[68:71], s39 offen sc1
    s_mov_b32 s39, 0
    buffer_load_dwordx2 v[108:109], v92, s[68:71], s39 offen sc1
    s_mov_b32 s39, 4718592
    buffer_load_dwordx2 v[112:113], v92, s[68:71], s39 offen sc1
    s_mov_b32 s39, 9437184
    buffer_load_dwordx4 v[116:119], v93, s[68:71], s39 offen sc1
    s_mov_b32 s39, 14155776
    buffer_load_dwordx4 v[120:123], v93, s[68:71], s39 offen sc1
    s_mov_b32 s14, 0xffff0000
    s_mov_b32 s15, 0xbfb8aa3b
    s_waitcnt lgkmcnt(0)
    v_add_f32 v20, v20, v24
    v_add_f32 v21, v21, v25
    v_add_f32 v22, v22, v26
    v_add_f32 v23, v23, v27
    v_add_f32 v60, v60, v64
    v_add_f32 v61, v61, v65
    v_add_f32 v62, v62, v66
    v_add_f32 v63, v63, v67
    v_add_f32 v100, v100, v104
    v_add_f32 v101, v101, v105
    v_add_f32 v102, v102, v106
    v_add_f32 v103, v103, v107
    s_waitcnt vmcnt(8)
    v_and_b32 v31, s14, v29
    v_lshlrev_b32 v30, 16, v29
    v_and_b32 v29, s14, v28
    v_lshlrev_b32 v28, 16, v28
    v_and_b32 v35, s14, v33
    v_lshlrev_b32 v34, 16, v33
    v_and_b32 v33, s14, v32
    v_lshlrev_b32 v32, 16, v32
    s_cmp_lg_u32 s33, 0
    s_cbranch_scc1 L_own_1
    v_mov_b32 v28, v20
    v_mov_b32 v29, v21
    v_mov_b32 v30, v22
    v_mov_b32 v31, v23
L_own_1:
    s_cmp_lg_u32 s33, 1
    s_cbranch_scc1 L_own_2
    v_mov_b32 v32, v20
    v_mov_b32 v33, v21
    v_mov_b32 v34, v22
    v_mov_b32 v35, v23
L_own_2:
    s_cmp_lg_u32 s33, 2
    s_cbranch_scc1 L_own_3
    v_mov_b32 v36, v20
    v_mov_b32 v37, v21
    v_mov_b32 v38, v22
    v_mov_b32 v39, v23
L_own_3:
    s_cmp_lg_u32 s33, 3
    s_cbranch_scc1 L_own_4
    v_mov_b32 v40, v20
    v_mov_b32 v41, v21
    v_mov_b32 v42, v22
    v_mov_b32 v43, v23
L_own_4:
    v_lshlrev_b32 v20, 16, v14
    v_and_b32 v21, s14, v14
    v_lshlrev_b32 v24, 16, v16
    v_and_b32 v25, s14, v16
    v_lshlrev_b32 v22, 16, v15
    v_and_b32 v23, s14, v15
    v_lshlrev_b32 v26, 16, v17
    v_and_b32 v27, s14, v17
    v_cvt_pk_bf16_f32 v44, v28, v29
    v_lshlrev_b32 v28, 16, v44
    v_and_b32 v29, s14, v44
    v_cvt_pk_bf16_f32 v45, v32, v33
    v_lshlrev_b32 v32, 16, v45
    v_and_b32 v33, s14, v45
    v_sub_f32 v28, v28, v32
    v_add_f32 v36, v36, v40
    v_sub_f32 v29, v29, v33
    v_add_f32 v37, v37, v41
    v_cvt_pk_bf16_f32 v44, v28, v29
    v_lshlrev_b32 v28, 16, v44
    v_and_b32 v29, s14, v44
    v_cvt_pk_bf16_f32 v45, v36, v37
    v_lshlrev_b32 v36, 16, v45
    v_and_b32 v37, s14, v45
    v_add_f32 v36, v36, v24
    v_add_f32 v37, v37, v25
    v_cvt_pk_bf16_f32 v45, v36, v37
    v_lshlrev_b32 v36, 16, v45
    v_and_b32 v37, s14, v45
    v_mul_f32 v46, s15, v36
    v_exp_f32 v46, v46
    v_mul_f32 v47, s15, v37
    v_exp_f32 v47, v47
    s_nop 0
    v_add_f32 v46, 1.0, v46
    v_rcp_f32 v46, v46
    v_add_f32 v47, 1.0, v47
    v_rcp_f32 v47, v47
    s_nop 0
    v_mul_f32 v36, v36, v46
    v_mul_f32 v37, v37, v47
    v_cvt_pk_bf16_f32 v45, v36, v37
    v_lshlrev_b32 v36, 16, v45
    v_and_b32 v37, s14, v45
    v_mul_f32 v28, v28, v36
    v_mul_f32 v29, v29, v37
    v_cvt_pk_bf16_f32 v44, v28, v29
    v_lshlrev_b32 v28, 16, v44
    v_and_b32 v29, s14, v44
    v_add_f32 v28, v28, v20
    v_add_f32 v29, v29, v21
    v_cvt_pk_bf16_f32 v14, v28, v29
    v_cvt_pk_bf16_f32 v44, v30, v31
    v_lshlrev_b32 v30, 16, v44
    v_and_b32 v31, s14, v44
    v_cvt_pk_bf16_f32 v45, v34, v35
    v_lshlrev_b32 v34, 16, v45
    v_and_b32 v35, s14, v45
    v_sub_f32 v30, v30, v34
    v_add_f32 v38, v38, v42
    v_sub_f32 v31, v31, v35
    v_add_f32 v39, v39, v43
    v_cvt_pk_bf16_f32 v44, v30, v31
    v_lshlrev_b32 v30, 16, v44
    v_and_b32 v31, s14, v44
    v_cvt_pk_bf16_f32 v45, v38, v39
    v_lshlrev_b32 v38, 16, v45
    v_and_b32 v39, s14, v45
    v_add_f32 v38, v38, v26
    v_add_f32 v39, v39, v27
    v_cvt_pk_bf16_f32 v45, v38, v39
    v_lshlrev_b32 v38, 16, v45
    v_and_b32 v39, s14, v45
    v_mul_f32 v46, s15, v38
    v_exp_f32 v46, v46
    v_mul_f32 v47, s15, v39
    v_exp_f32 v47, v47
    s_nop 0
    v_add_f32 v46, 1.0, v46
    v_rcp_f32 v46, v46
    v_add_f32 v47, 1.0, v47
    v_rcp_f32 v47, v47
    s_nop 0
    v_mul_f32 v38, v38, v46
    v_mul_f32 v39, v39, v47
    v_cvt_pk_bf16_f32 v45, v38, v39
    v_lshlrev_b32 v38, 16, v45
    v_and_b32 v39, s14, v45
    v_mul_f32 v30, v30, v38
    v_mul_f32 v31, v31, v39
    v_cvt_pk_bf16_f32 v44, v30, v31
    v_lshlrev_b32 v30, 16, v44
    v_and_b32 v31, s14, v44
    v_add_f32 v30, v30, v22
    v_add_f32 v31, v31, v23
    v_cvt_pk_bf16_f32 v15, v30, v31
    buffer_store_dwordx2 v[14:15], v12, s[60:63], 0 offen
    s_waitcnt vmcnt(4)
    v_and_b32 v71, s14, v69
    v_lshlrev_b32 v70, 16, v69
    v_and_b32 v69, s14, v68
    v_lshlrev_b32 v68, 16, v68
    v_and_b32 v75, s14, v73
    v_lshlrev_b32 v74, 16, v73
    v_and_b32 v73, s14, v72
    v_lshlrev_b32 v72, 16, v72
    s_cmp_lg_u32 s33, 0
    s_cbranch_scc1 L_own_5
    v_mov_b32 v68, v60
    v_mov_b32 v69, v61
    v_mov_b32 v70, v62
    v_mov_b32 v71, v63
L_own_5:
    s_cmp_lg_u32 s33, 1
    s_cbranch_scc1 L_own_6
    v_mov_b32 v72, v60
    v_mov_b32 v73, v61
    v_mov_b32 v74, v62
    v_mov_b32 v75, v63
L_own_6:
    s_cmp_lg_u32 s33, 2
    s_cbranch_scc1 L_own_7
    v_mov_b32 v76, v60
    v_mov_b32 v77, v61
    v_mov_b32 v78, v62
    v_mov_b32 v79, v63
L_own_7:
    s_cmp_lg_u32 s33, 3
    s_cbranch_scc1 L_own_8
    v_mov_b32 v80, v60
    v_mov_b32 v81, v61
    v_mov_b32 v82, v62
    v_mov_b32 v83, v63
L_own_8:
    v_lshlrev_b32 v60, 16, v54
    v_and_b32 v61, s14, v54
    v_lshlrev_b32 v64, 16, v56
    v_and_b32 v65, s14, v56
    v_lshlrev_b32 v62, 16, v55
    v_and_b32 v63, s14, v55
    v_lshlrev_b32 v66, 16, v57
    v_and_b32 v67, s14, v57
    v_cvt_pk_bf16_f32 v84, v68, v69
    v_lshlrev_b32 v68, 16, v84
    v_and_b32 v69, s14, v84
    v_cvt_pk_bf16_f32 v85, v72, v73
    v_lshlrev_b32 v72, 16, v85
    v_and_b32 v73, s14, v85
    v_sub_f32 v68, v68, v72
    v_add_f32 v76, v76, v80
    v_sub_f32 v69, v69, v73
    v_add_f32 v77, v77, v81
    v_cvt_pk_bf16_f32 v84, v68, v69
    v_lshlrev_b32 v68, 16, v84
    v_and_b32 v69, s14, v84
    v_cvt_pk_bf16_f32 v85, v76, v77
    v_lshlrev_b32 v76, 16, v85
    v_and_b32 v77, s14, v85
    v_add_f32 v76, v76, v64
    v_add_f32 v77, v77, v65
    v_cvt_pk_bf16_f32 v85, v76, v77
    v_lshlrev_b32 v76, 16, v85
    v_and_b32 v77, s14, v85
    v_mul_f32 v86, s15, v76
    v_exp_f32 v86, v86
    v_mul_f32 v87, s15, v77
    v_exp_f32 v87, v87
    s_nop 0
    v_add_f32 v86, 1.0, v86
    v_rcp_f32 v86, v86
    v_add_f32 v87, 1.0, v87
    v_rcp_f32 v87, v87
    s_nop 0
    v_mul_f32 v76, v76, v86
    v_mul_f32 v77, v77, v87
    v_cvt_pk_bf16_f32 v85, v76, v77
    v_lshlrev_b32 v76, 16, v85
    v_and_b32 v77, s14, v85
    v_mul_f32 v68, v68, v76
    v_mul_f32 v69, v69, v77
    v_cvt_pk_bf16_f32 v84, v68, v69
    v_lshlrev_b32 v68, 16, v84
    v_and_b32 v69, s14, v84
    v_add_f32 v68, v68, v60
    v_add_f32 v69, v69, v61
    v_cvt_pk_bf16_f32 v54, v68, v69
    v_cvt_pk_bf16_f32 v84, v70, v71
    v_lshlrev_b32 v70, 16, v84
    v_and_b32 v71, s14, v84
    v_cvt_pk_bf16_f32 v85, v74, v75
    v_lshlrev_b32 v74, 16, v85
    v_and_b32 v75, s14, v85
    v_sub_f32 v70, v70, v74
    v_add_f32 v78, v78, v82
    v_sub_f32 v71, v71, v75
    v_add_f32 v79, v79, v83
    v_cvt_pk_bf16_f32 v84, v70, v71
    v_lshlrev_b32 v70, 16, v84
    v_and_b32 v71, s14, v84
    v_cvt_pk_bf16_f32 v85, v78, v79
    v_lshlrev_b32 v78, 16, v85
    v_and_b32 v79, s14, v85
    v_add_f32 v78, v78, v66
    v_add_f32 v79, v79, v67
    v_cvt_pk_bf16_f32 v85, v78, v79
    v_lshlrev_b32 v78, 16, v85
    v_and_b32 v79, s14, v85
    v_mul_f32 v86, s15, v78
    v_exp_f32 v86, v86
    v_mul_f32 v87, s15, v79
    v_exp_f32 v87, v87
    s_nop 0
    v_add_f32 v86, 1.0, v86
    v_rcp_f32 v86, v86
    v_add_f32 v87, 1.0, v87
    v_rcp_f32 v87, v87
    s_nop 0
    v_mul_f32 v78, v78, v86
    v_mul_f32 v79, v79, v87
    v_cvt_pk_bf16_f32 v85, v78, v79
    v_lshlrev_b32 v78, 16, v85
    v_and_b32 v79, s14, v85
    v_mul_f32 v70, v70, v78
    v_mul_f32 v71, v71, v79
    v_cvt_pk_bf16_f32 v84, v70, v71
    v_lshlrev_b32 v70, 16, v84
    v_and_b32 v71, s14, v84
    v_add_f32 v70, v70, v62
    v_add_f32 v71, v71, v63
    v_cvt_pk_bf16_f32 v55, v70, v71
    buffer_store_dwordx2 v[54:55], v52, s[60:63], 0 offen
    s_waitcnt vmcnt(0)
    v_and_b32 v111, s14, v109
    v_lshlrev_b32 v110, 16, v109
    v_and_b32 v109, s14, v108
    v_lshlrev_b32 v108, 16, v108
    v_and_b32 v115, s14, v113
    v_lshlrev_b32 v114, 16, v113
    v_and_b32 v113, s14, v112
    v_lshlrev_b32 v112, 16, v112
    s_cmp_lg_u32 s33, 0
    s_cbranch_scc1 L_own_9
    v_mov_b32 v108, v100
    v_mov_b32 v109, v101
    v_mov_b32 v110, v102
    v_mov_b32 v111, v103
L_own_9:
    s_cmp_lg_u32 s33, 1
    s_cbranch_scc1 L_own_10
    v_mov_b32 v112, v100
    v_mov_b32 v113, v101
    v_mov_b32 v114, v102
    v_mov_b32 v115, v103
L_own_10:
    s_cmp_lg_u32 s33, 2
    s_cbranch_scc1 L_own_11
    v_mov_b32 v116, v100
    v_mov_b32 v117, v101
    v_mov_b32 v118, v102
    v_mov_b32 v119, v103
L_own_11:
    s_cmp_lg_u32 s33, 3
    s_cbranch_scc1 L_own_12
    v_mov_b32 v120, v100
    v_mov_b32 v121, v101
    v_mov_b32 v122, v102
    v_mov_b32 v123, v103
L_own_12:
    v_lshlrev_b32 v100, 16, v94
    v_and_b32 v101, s14, v94
    v_lshlrev_b32 v104, 16, v96
    v_and_b32 v105, s14, v96
    v_lshlrev_b32 v102, 16, v95
    v_and_b32 v103, s14, v95
    v_lshlrev_b32 v106, 16, v97
    v_and_b32 v107, s14, v97
    v_cvt_pk_bf16_f32 v124, v108, v109
    v_lshlrev_b32 v108, 16, v124
    v_and_b32 v109, s14, v124
    v_cvt_pk_bf16_f32 v125, v112, v113
    v_lshlrev_b32 v112, 16, v125
    v_and_b32 v113, s14, v125
    v_sub_f32 v108, v108, v112
    v_add_f32 v116, v116, v120
    v_sub_f32 v109, v109, v113
    v_add_f32 v117, v117, v121
    v_cvt_pk_bf16_f32 v124, v108, v109
    v_lshlrev_b32 v108, 16, v124
    v_and_b32 v109, s14, v124
    v_cvt_pk_bf16_f32 v125, v116, v117
    v_lshlrev_b32 v116, 16, v125
    v_and_b32 v117, s14, v125
    v_add_f32 v116, v116, v104
    v_add_f32 v117, v117, v105
    v_cvt_pk_bf16_f32 v125, v116, v117
    v_lshlrev_b32 v116, 16, v125
    v_and_b32 v117, s14, v125
    v_mul_f32 v126, s15, v116
    v_exp_f32 v126, v126
    v_mul_f32 v127, s15, v117
    v_exp_f32 v127, v127
    s_nop 0
    v_add_f32 v126, 1.0, v126
    v_rcp_f32 v126, v126
    v_add_f32 v127, 1.0, v127
    v_rcp_f32 v127, v127
    s_nop 0
    v_mul_f32 v116, v116, v126
    v_mul_f32 v117, v117, v127
    v_cvt_pk_bf16_f32 v125, v116, v117
    v_lshlrev_b32 v116, 16, v125
    v_and_b32 v117, s14, v125
    v_mul_f32 v108, v108, v116
    v_mul_f32 v109, v109, v117
    v_cvt_pk_bf16_f32 v124, v108, v109
    v_lshlrev_b32 v108, 16, v124
    v_and_b32 v109, s14, v124
    v_add_f32 v108, v108, v100
    v_add_f32 v109, v109, v101
    v_cvt_pk_bf16_f32 v94, v108, v109
    v_cvt_pk_bf16_f32 v124, v110, v111
    v_lshlrev_b32 v110, 16, v124
    v_and_b32 v111, s14, v124
    v_cvt_pk_bf16_f32 v125, v114, v115
    v_lshlrev_b32 v114, 16, v125
    v_and_b32 v115, s14, v125
    v_sub_f32 v110, v110, v114
    v_add_f32 v118, v118, v122
    v_sub_f32 v111, v111, v115
    v_add_f32 v119, v119, v123
    v_cvt_pk_bf16_f32 v124, v110, v111
    v_lshlrev_b32 v110, 16, v124
    v_and_b32 v111, s14, v124
    v_cvt_pk_bf16_f32 v125, v118, v119
    v_lshlrev_b32 v118, 16, v125
    v_and_b32 v119, s14, v125
    v_add_f32 v118, v118, v106
    v_add_f32 v119, v119, v107
    v_cvt_pk_bf16_f32 v125, v118, v119
    v_lshlrev_b32 v118, 16, v125
    v_and_b32 v119, s14, v125
    v_mul_f32 v126, s15, v118
    v_exp_f32 v126, v126
    v_mul_f32 v127, s15, v119
    v_exp_f32 v127, v127
    s_nop 0
    v_add_f32 v126, 1.0, v126
    v_rcp_f32 v126, v126
    v_add_f32 v127, 1.0, v127
    v_rcp_f32 v127, v127
    s_nop 0
    v_mul_f32 v118, v118, v126
    v_mul_f32 v119, v119, v127
    v_cvt_pk_bf16_f32 v125, v118, v119
    v_lshlrev_b32 v118, 16, v125
    v_and_b32 v119, s14, v125
    v_mul_f32 v110, v110, v118
    v_mul_f32 v111, v111, v119
    v_cvt_pk_bf16_f32 v124, v110, v111
    v_lshlrev_b32 v110, 16, v124
    v_and_b32 v111, s14, v124
    v_add_f32 v110, v110, v102
    v_add_f32 v111, v111, v103
    v_cvt_pk_bf16_f32 v95, v110, v111
    buffer_store_dwordx2 v[94:95], v92, s[60:63], 0 offen
L_k2_done:
    s_endpgm
.section .rodata,"a"
.p2align 6
.amdhsa_kernel ln_kernel
  .amdhsa_next_free_vgpr 72
  .amdhsa_next_free_sgpr 96
  .amdhsa_accum_offset 72
  .amdhsa_group_segment_fixed_size 0
  .amdhsa_kernarg_size 104
  .amdhsa_user_sgpr_count 2
  .amdhsa_user_sgpr_kernarg_segment_ptr 1
  .amdhsa_system_sgpr_workgroup_id_x 1
.end_amdhsa_kernel

.section .rodata,"a"
.p2align 6
.amdhsa_kernel gemm1_kernel
  .amdhsa_next_free_vgpr 256
  .amdhsa_next_free_sgpr 96
  .amdhsa_accum_offset 256
  .amdhsa_group_segment_fixed_size 0
  .amdhsa_kernarg_size 104
  .amdhsa_user_sgpr_count 2
  .amdhsa_user_sgpr_kernarg_segment_ptr 1
  .amdhsa_system_sgpr_workgroup_id_x 1
.end_amdhsa_kernel

.section .rodata,"a"
.p2align 6
.amdhsa_kernel gemm2_kernel
  .amdhsa_next_free_vgpr 256
  .amdhsa_next_free_sgpr 96
  .amdhsa_accum_offset 256
  .amdhsa_group_segment_fixed_size 0
  .amdhsa_kernarg_size 104
  .amdhsa_user_sgpr_count 2
  .amdhsa_user_sgpr_kernarg_segment_ptr 1
  .amdhsa_system_sgpr_workgroup_id_x 1
.end_amdhsa_kernel
```
